```python
import torch

def _softmax(x, axis=-1):
    return torch.softmax(x, dim=axis)

def _gelu(x):
    return torch.nn.functional.gelu(x, approximate='tanh')

def _silu(x):
    return torch.nn.functional.silu(x)

def _sigmoid(x):
    return torch.sigmoid(x)

def _layernorm(x, axis=-1, eps=1e-05):
    m = x.mean(dim=axis, keepdim=True)
    v = x.var(dim=axis, keepdim=True, unbiased=False)
    return (x - m) / torch.sqrt(v + eps)

def _scatter_add(tgt, idx, src, axis=0):
    return tgt.clone().index_add_(axis, idx, src)

def _segment_sum(src, seg, n):
    out = torch.zeros((n,) + src.shape[1:], dtype=src.dtype)
    return out.index_add_(0, seg, src)

def _pad(x, pw):
    flat = tuple((v for pair in reversed(pw) for v in pair))
    return torch.nn.functional.pad(x, flat)
kernel_name = 'standalone__mixer_gmlp__prompt'

def setup_inputs():

    _w = lambda a: (lambda t: t.to(torch.bfloat16) if t.is_floating_point() else t)(torch.as_tensor(a))
    B, S, D, F = (1, 2048, 640, 1536)
    Fh = F // 2
    return {'x': _w((lambda *s: torch.randn(*s, dtype=torch.bfloat16) * 0.05)(B, S, D)), 'w_in': _w((lambda *s: torch.randn(*s, dtype=torch.bfloat16) * 0.4)(D, 2 * Fh)), 'w_sp': _w(0.01 * (lambda *s: torch.randn(*s, dtype=torch.bfloat16) * 0.4)(S, S)), 'b_sp': _w(1.0 + 0.01 * (lambda *s: torch.randn(*s, dtype=torch.bfloat16) * 0.05)(S)), 'w_out': _w((lambda *s: torch.randn(*s, dtype=torch.bfloat16) * 0.05)(Fh, D))}

def reference(x, w_in, w_sp, b_sp, w_out):
    B, S, D = x.shape
    F = w_in.shape[-1]
    Fh = F // 2
    z = _gelu(torch.einsum('bsd,df->bsf', x, w_in))
    z1 = z[..., :Fh].clone()
    z2 = _layernorm(z[..., Fh:], axis=-1)
    g = torch.einsum('ts,bsf->btf', w_sp, z2) + b_sp[None, :, None]
    return torch.einsum('bsf,fd->bsd', z1 * g, w_out)
```

```asm
; @launch grid=(256,1,1) block=(256,1,1) lds=163840
.amdgcn_target "amdgcn-amd-amdhsa--gfx950"
.text
.globl standalone__mixer_gmlp__prompt_kernel
.p2align 12
.p2align 8
.type standalone__mixer_gmlp__prompt_kernel,@function
standalone__mixer_gmlp__prompt_kernel:
L_go:
    s_load_dwordx2 s[4:5], s[0:1], 0
    s_load_dwordx2 s[8:9], s[0:1], 8
    s_load_dwordx2 s[16:17], s[0:1], 56
    s_load_dwordx2 s[24:25], s[0:1], 32
    s_load_dwordx2 s[28:29], s[0:1], 24
    s_load_dwordx2 s[12:13], s[0:1], 16
    s_load_dwordx2 s[20:21], s[0:1], 40
    s_cmp_ge_u32 s2, 256
    s_cbranch_scc1 L_exit
    v_lshrrev_b32 v4, 6, v0
    v_and_b32 v1, 63, v0
    v_readfirstlane_b32 s48, v4
    s_lshr_b32 s55, s2, 3
    s_getpc_b64 s[68:69]
    s_and_b32 s56, s55, 7
    s_lshl_b32 s56, s56, 12
    v_and_b32 v5, 7, v1
    v_lshl_add_u32 v4, v4, 3, v5
    v_lshl_add_u32 v4, v4, 7, s56
    v_min_u32 v4, L_code_end-standalone__mixer_gmlp__prompt_kernel-256, v4
    v_mov_b32 v213, s69
    v_add_co_u32 v212, vcc, s68, v4
    v_lshlrev_b32_e64 v2, 4, v1
    s_bfe_u32 s56, s2, 0x10001
    v_addc_co_u32 v213, vcc, 0, v213, vcc
    global_load_dword v214, v[212:213], off
    s_bfe_u32 s54, s2, 0x10002
    s_and_b32 s50, s2, 1
    s_lshl1_add_u32 s54, s54, s50
    s_mul_i32 s49, s55, 86
    s_sub_u32 s49, s49, 688
    s_lshr_b32 s49, s49, 8
    s_mul_i32 s57, s49, -3
    s_add_u32 s57, s57, s55
    s_sub_u32 s57, s57, 8
    s_cmp_lt_u32 s55, 8
    s_cselect_b32 s57, 3, s57
    s_cselect_b32 s55, s55, s49
    s_lshl2_add_u32 s50, s56, s57
    s_lshl3_add_u32 s49, s54, s55
    s_mul_i32 s72, s48, 24576
    s_add_u32 s72, s72, 65536
    s_lshl_b32 s73, s48, 12
    s_cmp_eq_u32 s57, 3
    s_cbranch_scc1 L_free
    s_and_b32 s54, s49, 1
    s_mul_i32 s71, s54, 0xfffd8000
    s_add_u32 s71, s71, 81920
    s_lshl1_add_u32 s54, s56, s54
    s_mul_i32 s54, s54, 3
    s_add_u32 s52, s54, s57
    s_lshr_b32 s55, s49, 1
    s_lshl2_add_u32 s51, s55, s48
    s_add_u32 s54, s55, s52
    s_and_b32 s54, s54, 3
    s_lshl_b32 s54, s54, 2
    s_lshr_b32 s54, 0, s54
    s_and_b32 s54, s54, 15
    s_lshr_b32 s55, s49, 3
    s_mul_i32 s55, s55, 3
    s_add_u32 s54, s54, s55
    s_mul_i32 s55, s56, 1
    s_add_u32 s54, s54, s55
    s_mul_i32 s55, s54, 52
    s_lshr_b32 s55, s55, 8
    s_mul_i32 s55, s55, 5
    s_sub_u32 s53, s54, s55
    s_lshl2_add_u32 s55, s49, s48
    s_mul_i32 s55, s55, 20480
    s_lshl_b32 s57, s53, 8
    s_add_u32 s58, s55, s57
    s_lshl4_add_u32 s56, s53, s48
    s_mul_i32 s56, s56, 24576
    s_lshl_b32 s57, s52, 7
    s_add_u32 s63, s56, s57
    v_lshrrev_b32 v4, 4, v1
    v_mul_u32_u24 v4, 1280, v4
    v_and_b32 v5, 0x30, v1
    v_and_b32 v6, 0xf0, v2
    v_xor_b32 v5, v5, v6
    v_add_u32 v12, v4, v5
    v_xor_b32_e64 v4, 64, v12
    v_add_u32 v13, 4096, v4
    v_xor_b32 v4, 128, v12
    v_add_u32 v14, 8192, v4
    v_xor_b32 v4, 192, v12
    v_add_u32 v15, 12288, v4
    s_mov_b32 s6, 2621440
    s_mov_b32 s7, 0x20000
    s_mov_b32 s10, 1966080
    s_mov_b32 s11, 0x20000
    s_add_u32 m0, s72, 0
    s_waitcnt lgkmcnt(0)
    buffer_load_dwordx4 v12, s[4:7], s58 offen offset:0 lds
    buffer_load_dwordx4 v13, s[4:7], s58 offen offset:1024 lds
    buffer_load_dwordx4 v14, s[4:7], s58 offen offset:2048 lds
    s_branch L_busy2
L_free:
    s_nop 0
    s_mov_b32 s6, 2621440
    s_mov_b32 s7, 0x20000
    s_mov_b32 s10, 1966080
    s_mov_b32 s11, 0x20000
    s_lshl1_add_u32 s52, s49, s56
    s_mov_b32 s54, 0
    s_lshr_b32 s55, s49, 3
    s_mul_i32 s55, s55, 3
    s_add_u32 s54, s54, s55
    s_mul_i32 s55, s56, 1
    s_add_u32 s54, s54, s55
    s_mul_i32 s55, s54, 52
    s_lshr_b32 s55, s55, 8
    s_mul_i32 s55, s55, 5
    s_sub_u32 s51, s54, s55
    s_lshl2_add_u32 s54, s49, s48
    s_mul_i32 s55, s54, 20480
    s_lshl_b32 s57, s51, 8
    s_add_u32 s58, s55, s57
    s_and_b32 s54, s54, 31
    s_lshl_b32 s55, s51, 5
    s_add_u32 s54, s54, s55
    s_mul_i32 s54, s54, 12288
    s_mul_i32 s55, s56, 768
    s_add_u32 s63, s54, s55
    s_add_u32 s51, s51, 1
    s_mul_i32 s54, s51, 52
    s_lshr_b32 s54, s54, 8
    s_mul_i32 s54, s54, -5
    s_add_u32 s54, s54, 1
    s_lshl_b32 s55, s54, 8
    s_add_u32 s59, s58, s55
    s_nop 0
    s_mul_i32 s54, s54, 393216
    s_add_u32 s64, s63, s54
    s_add_u32 s51, s51, 1
    s_mul_i32 s54, s51, 52
    s_lshr_b32 s54, s54, 8
    s_mul_i32 s54, s54, -5
    s_add_u32 s54, s54, 2
    s_lshl_b32 s55, s54, 8
    s_add_u32 s60, s58, s55
    s_mul_i32 s54, s54, 393216
    s_add_u32 s65, s63, s54
    s_add_u32 s51, s51, 1
    s_mul_i32 s54, s51, 52
    s_lshr_b32 s54, s54, 8
    s_mul_i32 s54, s54, -5
    s_add_u32 s54, s54, 3
    s_lshl_b32 s55, s54, 8
    s_add_u32 s61, s58, s55
    s_mul_i32 s54, s54, 393216
    s_add_u32 s66, s63, s54
    s_add_u32 s51, s51, 1
    s_mul_i32 s54, s51, 52
    s_lshr_b32 s54, s54, 8
    s_mul_i32 s54, s54, -5
    s_add_u32 s54, s54, 4
    s_lshl_b32 s55, s54, 8
    s_add_u32 s62, s58, s55
    s_mul_i32 s54, s54, 393216
    s_add_u32 s67, s63, s54
    v_bfe_u32 v4, v1, 1, 4
    v_mul_u32_u24 v4, 1280, v4
    v_and_b32 v5, 1, v1
    v_lshl_add_u32 v12, v5, 7, v4
    v_bfe_u32 v4, v1, 3, 2
    v_mul_u32_u24 v4, 3072, v4
    v_and_b32 v5, 7, v1
    v_min_u32 v5, 5, v5
    v_lshl_add_u32 v20, v5, 7, v4
    s_waitcnt lgkmcnt(0)
    buffer_load_dword v53, v12, s[4:7], s59 offen
    buffer_load_dword v58, v20, s[8:11], s64 offen offset:1536
    buffer_load_dword v54, v12, s[4:7], s60 offen
    s_nop 0
    buffer_load_dword v59, v20, s[8:11], s65 offen offset:1536
    s_branch L_free2
L_busy2:
    v_lshrrev_b32 v4, 3, v1
    v_mul_u32_u24 v4, 3072, v4
    v_and_b32 v5, 0x70, v2
    v_add_u32 v4, v4, v5
    v_and_b32 v5, 16, v1
    v_lshlrev_b32 v5, 1, v5
    s_and_b32 s54, s48, 1
    v_lshl_add_u32 v5, s54, 6, v5
    v_xor_b32_e64 v20, v4, v5
    v_add_u32 v21, 97280, v20
    v_add_u32 v22, 194560, v20
    v_add_u32 v23, 291840, v20
    buffer_load_dwordx4 v15, s[4:7], s58 offen offset:3072 lds
    s_add_u32 s53, s53, 1
    s_mul_i32 s54, s53, 52
    s_lshr_b32 s54, s54, 8
    s_mul_i32 s54, s54, -5
    s_add_u32 s54, s54, 1
    s_lshl_b32 s55, s54, 8
    s_add_u32 s59, s58, s55
    s_nop 0
    s_add_u32 m0, s72, 4096
    s_add_u32 s74, s58, s71
    buffer_load_dwordx4 v12, s[4:7], s74 offen offset:0 lds
    s_mul_i32 s54, s54, 393216
    s_add_u32 s64, s63, s54
    s_add_u32 s53, s53, 1
    s_mul_i32 s54, s53, 52
    s_lshr_b32 s54, s54, 8
    s_mul_i32 s54, s54, -5
    s_add_u32 s54, s54, 2
    buffer_load_dwordx4 v13, s[4:7], s74 offen offset:1024 lds
    s_lshl_b32 s55, s54, 8
    s_add_u32 s60, s58, s55
    s_mul_i32 s54, s54, 393216
    s_add_u32 s65, s63, s54
    s_add_u32 s53, s53, 1
    s_mul_i32 s54, s53, 52
    s_lshr_b32 s54, s54, 8
    s_nop 0
    buffer_load_dwordx4 v14, s[4:7], s74 offen offset:2048 lds
    s_mul_i32 s54, s54, -5
    s_add_u32 s54, s54, 3
    s_lshl_b32 s55, s54, 8
    s_add_u32 s61, s58, s55
    s_mul_i32 s54, s54, 393216
    s_add_u32 s66, s63, s54
    s_add_u32 s53, s53, 1
    buffer_load_dwordx4 v15, s[4:7], s74 offen offset:3072 lds
    s_mul_i32 s54, s53, 52
    s_lshr_b32 s54, s54, 8
    s_mul_i32 s54, s54, -5
    s_add_u32 s54, s54, 4
    s_lshl_b32 s55, s54, 8
    s_add_u32 s62, s58, s55
    s_mul_i32 s54, s54, 393216
    s_add_u32 m0, s73, 0
    s_add_u32 s74, s63, 1536
    s_nop 0
    buffer_load_dwordx4 v20, s[8:11], s74 offen offset:0 lds
    s_add_u32 s67, s63, s54
    s_mov_b32 s18, 16777216
    s_mov_b32 s19, 0x20000
    s_nop 0
    s_mov_b32 s30, 4096
    s_mov_b32 s31, 0x20000
    s_mov_b32 s14, 8388608
    s_mov_b32 s15, 0x20000
    buffer_load_dwordx4 v21, s[8:11], s74 offen offset:1024 lds
    s_mov_b32 s22, 2621440
    s_mov_b32 s23, 0x20000
    v_and_b32 v4, 15, v1
    v_lshrrev_b32 v5, 4, v1
    v_xor_b32 v6, v4, v5
    v_lshlrev_b32 v6, 4, v6
    v_lshl_add_u32 v6, v4, 8, v6
    buffer_load_dwordx4 v22, s[8:11], s74 offen offset:2048 lds
    v_add_u32 v8, s72, v6
    v_xor_b32 v9, 64, v8
    v_xor_b32 v10, 128, v8
    v_xor_b32 v11, 192, v8
    v_bfe_u32 v4, v1, 2, 2
    v_lshlrev_b32_e64 v4, 7, v4
    v_lshl_add_u32 v4, v5, 12, v4
    buffer_load_dwordx4 v23, s[8:11], s74 offen offset:3072 lds
    v_bfe_u32 v5, v1, 3, 2
    v_lshl_add_u32 v4, v5, 5, v4
    v_and_b32 v5, 3, v1
    v_lshl_add_u32 v24, v5, 3, v4
    v_xor_b32 v25, 32, v24
    v_xor_b32_e64 v26, 64, v24
    v_xor_b32 v27, 96, v24
    s_mul_i32 s54, s49, 98304
    s_lshl_b32 s55, s48, 13
    s_add_u32 s54, s54, s55
    s_add_u32 s77, s54, 5242880
    s_lshl_b32 s55, s50, 10
    s_add_u32 s78, s77, s55
    v_mov_b32 v4, 0
    buffer_load_dword v43, v4, s[16:19], 0 offen offset:0 sc1
    s_lshl2_add_u32 s54, s49, s48
    s_lshl_b32 s54, s54, 5
    v_and_b32 v4, 15, v1
    v_lshlrev_b32_e64 v4, 1, v4
    buffer_load_ushort v40, v4, s[28:31], s54 offen
    v_lshrrev_b32 v4, 4, v1
    v_mul_u32_u24 v4, 4096, v4
    v_and_b32 v5, 0x30, v1
    v_and_b32 v6, 0xf0, v2
    v_xor_b32 v5, v5, v6
    v_add_u32 v16, v4, v5
    v_xor_b32_e64 v4, 64, v16
    v_add_u32 v17, 15360, v4
    v_xor_b32 v4, 128, v16
    v_add_u32 v18, 30720, v4
    v_xor_b32 v4, 192, v16
    v_add_u32 v19, 46080, v4
    s_lshl_b32 s54, s48, 15
    s_nop 0
    s_add_u32 s47, s54, 2097152
    s_lshl_b32 s54, s49, 18
    s_lshl_b32 s55, s48, 10
    s_add_u32 s35, s54, s55
    s_lshl_b32 s55, s50, 2
    s_lshr_b32 s53, 572653568, s55
    s_add_u32 s54, s53, 0
    s_and_b32 s54, s54, 3
    s_lshl_b32 s55, s54, 8
    s_lshl_b32 s54, s54, 13
    s_add_u32 s32, s35, s55
    s_add_u32 s40, s47, s54
    s_add_u32 s41, s40, 4096
    s_xor_b32 s54, s48, 0
    s_lshl_b32 s36, s54, 16
    s_mul_i32 s54, s54, 6144
    s_add_u32 s54, s54, 98304
    v_add_u32_e64 v28, s54, v2
    s_add_u32 m0, s72, 8192
    s_nop 0
    buffer_load_dwordx4 v12, s[4:7], s59 offen offset:0 lds
    buffer_load_dwordx4 v13, s[4:7], s59 offen offset:1024 lds
    s_nop 0
    buffer_load_dwordx4 v14, s[4:7], s59 offen offset:2048 lds
    s_add_u32 s54, s53, 2
    s_and_b32 s54, s54, 3
    s_lshl_b32 s55, s54, 8
    s_lshl_b32 s54, s54, 13
    s_add_u32 s33, s35, s55
    s_add_u32 s42, s47, s54
    s_add_u32 s43, s42, 4096
    s_xor_b32 s54, s48, 1
    s_lshl_b32 s37, s54, 16
    s_mul_i32 s54, s54, 6144
    s_add_u32 s54, s54, 98304
    v_add_u32 v29, s54, v2
    buffer_load_dwordx4 v15, s[4:7], s59 offen offset:3072 lds
    s_add_u32 s54, s53, 1
    s_and_b32 s54, s54, 3
    s_lshl_b32 s55, s54, 8
    s_lshl_b32 s54, s54, 13
    s_add_u32 s34, s35, s55
    s_add_u32 s44, s47, s54
    s_add_u32 s45, s44, 4096
    s_xor_b32 s54, s48, 2
    s_lshl_b32 s38, s54, 16
    s_mul_i32 s54, s54, 6144
    s_nop 0
    s_add_u32 s54, s54, 98304
    v_add_u32 v30, s54, v2
    s_add_u32 s54, s53, 3
    s_and_b32 s54, s54, 3
    s_lshl_b32 s55, s54, 8
    s_lshl_b32 s54, s54, 13
    s_add_u32 s35, s35, s55
    s_add_u32 s46, s47, s54
    s_add_u32 s47, s46, 4096
    s_xor_b32 s54, s48, 3
    s_lshl_b32 s39, s54, 16
    s_mul_i32 s54, s54, 6144
    s_nop 0
    s_add_u32 s54, s54, 98304
    v_add_u32 v31, s54, v2
    s_add_u32 m0, s72, 12288
    s_add_u32 s74, s59, s71
    buffer_load_dwordx4 v12, s[4:7], s74 offen offset:0 lds
    s_mul_i32 s1, s48, 10240
    s_lshl3_add_u32 s54, s49, s50
    s_lshl_b32 s54, s54, 7
    s_add_u32 s81, s54, 65536
    s_mov_b32 s68, 0xbdd2d3e8
    s_mov_b32 s69, 0xbdd2d3e8
    v_mov_b32 v36, 0xc0135761
    v_mov_b32 v37, 0xc0135761
    buffer_load_dwordx4 v13, s[4:7], s74 offen offset:1024 lds
    s_and_b32 s80, s49, 1
    s_and_b32 s54, s50, 3
    s_lshl2_add_u32 s79, s80, s54
    s_lshl_b32 s79, s79, 2
    s_lshr_b32 s79, 0x4a86a420, s79
    s_and_b32 s79, s79, 15
    s_mul_i32 s80, s80, -6
    s_add_u32 s80, s80, s54
    s_lshr_b32 s54, s50, 2
    s_mul_i32 s54, s54, 12
    s_add_u32 s79, s79, s54
    s_add_u32 s80, s80, s54
    s_add_u32 s80, s80, 6
    buffer_load_dwordx4 v14, s[4:7], s74 offen offset:2048 lds
    v_lshl_add_u32 v3, s79, 17, v2
    v_add_u32 v47, 131072, v3
    v_lshl_add_u32 v46, s80, 17, v2
    s_lshr_b32 s54, s79, 1
    s_lshr_b32 s55, s80, 1
    s_sub_u32 s54, s54, s55
    v_bfe_u32 v4, v1, 2, 1
    v_mul_lo_u32 v4, s54, v4
    v_add_u32 v4, s55, v4
    v_and_b32_e64 v5, 3, v1
    v_lshl_add_u32 v5, s48, 2, v5
    v_lshl_add_u32 v5, v4, 4, v5
    v_lshlrev_b32 v5, 7, v5
    v_add_u32 v48, 1572864, v5
    v_mov_b32 v44, s55
    s_waitcnt vmcnt(17)
    ds_read_b128 a[160:163], v8 offset:0
    ds_read_b128 a[168:171], v9 offset:0
    ds_read_b128 a[176:179], v10 offset:0
    s_nop 0
    ds_read_b128 a[184:187], v11 offset:0
    buffer_load_dwordx4 v15, s[4:7], s74 offen offset:3072 lds
    s_lshl2_add_u32 s54, s49, s48
    s_mul_i32 s54, s54, 24
    s_add_u32 s79, s79, s54
    s_lshl_b32 s79, s79, 10
    s_add_u32 s79, s79, 8388608
    s_add_u32 s80, s80, s54
    s_lshl_b32 s80, s80, 10
    s_add_u32 s80, s80, 8388608
    s_add_u32 m0, s73, 16384
    s_add_u32 s74, s64, 1536
    buffer_load_dwordx4 v20, s[8:11], s74 offen offset:0 lds
    v_mul_u32_u24 v4, 86, v44
    v_lshrrev_b32 v4, 8, v4
    v_mul_u32_u24 v5, 3, v4
    v_sub_u32 v5, v44, v5
    v_lshrrev_b32 v6, 1, v4
    v_lshl_add_u32 v5, v6, 2, v5
    v_and_b32 v4, 1, v4
    s_and_b32 s54, s49, 30
    v_add_u32_e64 v4, s54, v4
    v_lshl_add_u32 v4, v4, 3, v5
    v_lshlrev_b32 v4, 7, v4
    v_add_u32 v44, 65536, v4
    buffer_load_dwordx4 v21, s[8:11], s74 offen offset:1024 lds
    s_or_b32 s54, s50, 3
    s_add_u32 s54, s54, 1
    s_cmp_lt_u32 s48, 2
    s_cselect_b32 s54, s50, s54
    s_lshr_b32 s55, s50, 2
    s_add_u32 s54, s54, s55
    s_and_b32 s55, s48, 1
    s_lshl1_add_u32 s54, s54, s55
    s_mul_i32 s54, s54, 3
    v_and_b32 v4, 3, v1
    v_min_u32 v4, 2, v4
    v_add_u32 v4, s54, v4
    v_and_b32 v5, 15, v1
    v_lshl_add_u32 v5, s48, 4, v5
    s_or_b32 s54, s49, s50
    s_cmp_eq_u32 s54, 0
    s_cselect_b64 vcc, -1, 0
    v_cndmask_b32 v4, v4, v5, vcc
    v_lshl_add_u32 v45, v4, 2, 3
    buffer_load_dwordx4 v22, s[8:11], s74 offen offset:2048 lds
    s_lshl2_add_u32 s54, s49, s48
    v_cmp_gt_u32 vcc, 32, v1
    v_and_b32 v4, 1, v1
    v_lshl_add_u32 v4, s54, 1, v4
    v_cndmask_b32 v4, v45, v4, vcc
    v_lshlrev_b32 v4, 7, v4
    v_add_u32 v45, 65536, v4
    v_cmp_gt_u32 vcc, 16, v1
    s_nop 1
    v_cndmask_b32 v45, v45, v44, vcc
    v_mov_b32 v4, 1073741824
    v_cmp_eq_u32 vcc, 0, v0
    s_nop 1
    v_cndmask_b32 v0, v4, v0, vcc
    buffer_load_dwordx4 v23, s[8:11], s74 offen offset:3072 lds
    s_add_u32 m0, s72, 16384
    s_nop 0
    buffer_load_dwordx4 v12, s[4:7], s60 offen offset:0 lds
    s_waitcnt vmcnt(19)
    ds_read_b128 a[164:167], v8 offset:4096
    ds_read_b128 a[172:175], v9 offset:4096
    ds_read_b128 a[180:183], v10 offset:4096
    ds_read_b128 a[188:191], v11 offset:4096
    buffer_load_dwordx4 v13, s[4:7], s60 offen offset:1024 lds
    buffer_load_dwordx4 v14, s[4:7], s60 offen offset:2048 lds
    s_waitcnt vmcnt(17)
    s_barrier
    buffer_load_dwordx4 v15, s[4:7], s60 offen offset:3072 lds
    ds_read_b64_tr_b16 v[148:149], v24 offset:0
    ds_read_b64_tr_b16 v[150:151], v24 offset:512
    ds_read_b64_tr_b16 v[152:153], v25 offset:0
    ds_read_b64_tr_b16 v[154:155], v25 offset:512
    ds_read_b64_tr_b16 v[156:157], v26 offset:0
    ds_read_b64_tr_b16 v[158:159], v26 offset:512
    ds_read_b64_tr_b16 v[160:161], v27 offset:0
    ds_read_b64_tr_b16 v[162:163], v27 offset:512
    s_waitcnt vmcnt(17)
    s_nop 0
    v_add_u32 v43, 0x7b4a3d25, v43
    s_waitcnt vmcnt(16)
    v_lshlrev_b32_e64 v40, 16, v40
    s_add_u32 m0, s72, 20480
    s_add_u32 s74, s60, s71
    buffer_load_dwordx4 v12, s[4:7], s74 offen offset:0 lds
    s_waitcnt lgkmcnt(4)
    v_mfma_f32_16x16x32_bf16 v[116:119], a[160:163], v[148:151], 0
    ds_read_b64_tr_b16 v[164:165], v24 offset:1024
    s_nop 0
    v_mfma_f32_16x16x32_bf16 v[120:123], a[164:167], v[148:151], 0
    ds_read_b64_tr_b16 v[166:167], v24 offset:1536
    v_mfma_f32_16x16x32_bf16 v[124:127], a[160:163], v[152:155], 0
    buffer_load_dwordx4 v13, s[4:7], s74 offen offset:1024 lds
    ds_read_b64_tr_b16 v[168:169], v25 offset:1024
    v_mfma_f32_16x16x32_bf16 v[128:131], a[164:167], v[152:155], 0
    ds_read_b64_tr_b16 v[170:171], v25 offset:1536
    s_waitcnt lgkmcnt(4)
    s_nop 0
    v_mfma_f32_16x16x32_bf16 v[132:135], a[160:163], v[156:159], 0
    ds_read_b64_tr_b16 v[172:173], v26 offset:1024
    v_mfma_f32_16x16x32_bf16 v[136:139], a[164:167], v[156:159], 0
    ds_read_b64_tr_b16 v[174:175], v26 offset:1536
    v_mfma_f32_16x16x32_bf16 v[140:143], a[160:163], v[160:163], 0
    buffer_load_dwordx4 v14, s[4:7], s74 offen offset:2048 lds
    ds_read_b64_tr_b16 v[176:177], v27 offset:1024
    v_mfma_f32_16x16x32_bf16 v[144:147], a[164:167], v[160:163], 0
    ds_read_b64_tr_b16 v[178:179], v27 offset:1536
    s_waitcnt lgkmcnt(4)
    v_mfma_f32_16x16x32_bf16 v[116:119], a[168:171], v[164:167], v[116:119]
    ds_read_b64_tr_b16 v[148:149], v24 offset:2048
    s_nop 0
    v_mfma_f32_16x16x32_bf16 v[120:123], a[172:175], v[164:167], v[120:123]
    ds_read_b64_tr_b16 v[150:151], v24 offset:2560
    v_mfma_f32_16x16x32_bf16 v[124:127], a[168:171], v[168:171], v[124:127]
    buffer_load_dwordx4 v15, s[4:7], s74 offen offset:3072 lds
    ds_read_b64_tr_b16 v[152:153], v25 offset:2048
    v_mfma_f32_16x16x32_bf16 v[128:131], a[172:175], v[168:171], v[128:131]
    ds_read_b64_tr_b16 v[154:155], v25 offset:2560
    s_waitcnt lgkmcnt(4)
    s_nop 0
    v_mfma_f32_16x16x32_bf16 v[132:135], a[168:171], v[172:175], v[132:135]
    ds_read_b64_tr_b16 v[156:157], v26 offset:2048
    v_mfma_f32_16x16x32_bf16 v[136:139], a[172:175], v[172:175], v[136:139]
    ds_read_b64_tr_b16 v[158:159], v26 offset:2560
    s_add_u32 m0, s73, 32768
    s_add_u32 s74, s65, 1536
    buffer_load_dwordx4 v20, s[8:11], s74 offen offset:0 lds
    v_mfma_f32_16x16x32_bf16 v[140:143], a[168:171], v[176:179], v[140:143]
    ds_read_b64_tr_b16 v[160:161], v27 offset:2048
    v_mfma_f32_16x16x32_bf16 v[144:147], a[172:175], v[176:179], v[144:147]
    ds_read_b64_tr_b16 v[162:163], v27 offset:2560
    s_waitcnt lgkmcnt(4)
    s_nop 0
    v_mfma_f32_16x16x32_bf16 v[116:119], a[176:179], v[148:151], v[116:119]
    ds_read_b64_tr_b16 v[164:165], v24 offset:3072
    v_mfma_f32_16x16x32_bf16 v[120:123], a[180:183], v[148:151], v[120:123]
    buffer_load_dwordx4 v21, s[8:11], s74 offen offset:1024 lds
    ds_read_b64_tr_b16 v[166:167], v24 offset:3584
    v_mfma_f32_16x16x32_bf16 v[124:127], a[176:179], v[152:155], v[124:127]
    ds_read_b64_tr_b16 v[168:169], v25 offset:3072
    s_waitcnt vmcnt(18)
    s_nop 0
    ds_read_b128 a[192:195], v8 offset:8192
    ds_read_b128 a[200:203], v9 offset:8192
    ds_read_b128 a[208:211], v10 offset:8192
    ds_read_b128 a[216:219], v11 offset:8192
    v_mfma_f32_16x16x32_bf16 v[128:131], a[180:183], v[152:155], v[128:131]
    ds_read_b64_tr_b16 v[170:171], v25 offset:3584
    buffer_load_dwordx4 v22, s[8:11], s74 offen offset:2048 lds
    s_waitcnt lgkmcnt(8)
    s_nop 0
    v_mfma_f32_16x16x32_bf16 v[132:135], a[176:179], v[156:159], v[132:135]
    ds_read_b64_tr_b16 v[172:173], v26 offset:3072
    v_mfma_f32_16x16x32_bf16 v[136:139], a[180:183], v[156:159], v[136:139]
    ds_read_b64_tr_b16 v[174:175], v26 offset:3584
    v_mfma_f32_16x16x32_bf16 v[140:143], a[176:179], v[160:163], v[140:143]
    ds_read_b64_tr_b16 v[176:177], v27 offset:3072
    v_mfma_f32_16x16x32_bf16 v[144:147], a[180:183], v[160:163], v[144:147]
    buffer_load_dwordx4 v23, s[8:11], s74 offen offset:3072 lds
    ds_read_b64_tr_b16 v[178:179], v27 offset:3584
    s_mul_i32 s54, s51, 3072
    s_add_u32 s75, s54, 131072
    s_lshl_b32 s54, s52, 18
    s_lshl2_add_u32 s55, s49, s48
    s_lshr_b32 s55, s55, 1
    s_lshl_b32 s55, s55, 11
    s_add_u32 s54, s54, s55
    s_and_b32 s55, s48, 1
    s_lshl_b32 s55, s55, 9
    s_add_u32 s54, s54, s55
    s_add_u32 s76, s54, 2097152
    s_lshr_b32 s54, s49, 1
    s_lshl4_add_u32 s54, s52, s54
    s_lshl_b32 s54, s54, 7
    s_add_u32 s0, s54, 1572864
    v_and_b32 v4, 0xf0, v2
    s_nop 0
    v_bfe_u32 v5, v1, 4, 1
    v_lshl_add_u32 v4, v5, 10, v4
    v_lshrrev_b32 v5, 5, v1
    v_lshl_add_u32 v38, v5, 8, v4
    s_add_u32 m0, s72, 0
    s_nop 0
    buffer_load_dwordx4 v12, s[4:7], s61 offen offset:0 lds
    v_and_b32_e64 v4, 3, v1
    v_add_u32 v33, 0x07060500, v4
    s_lshl_b32 s54, s52, 8
    v_lshl_add_u32 v42, v1, 2, s54
    v_lshrrev_b32_e64 v5, 4, v1
    v_lshl_add_u32 v4, v5, 2, v4
    v_bfe_u32 v5, v1, 2, 2
    v_lshl_add_u32 v4, v5, 4, v4
    v_lshlrev_b32 v41, 4, v4
    s_and_b32 s54, s49, 1
    s_lshl_b32 s54, s54, 5
    v_xor_b32 v42, s54, v42
    v_xor_b32 v41, s54, v41
    s_waitcnt vmcnt(17)
    ds_read_b128 a[196:199], v8 offset:12288
    ds_read_b128 a[204:207], v9 offset:12288
    ds_read_b128 a[212:215], v10 offset:12288
    ds_read_b128 a[220:223], v11 offset:12288
    buffer_load_dwordx4 v13, s[4:7], s61 offen offset:1024 lds
    s_waitcnt vmcnt(14)
    buffer_load_dwordx4 v14, s[4:7], s61 offen offset:2048 lds
    s_waitcnt lgkmcnt(4)
    s_barrier
    s_nop 0
    v_mfma_f32_16x16x32_bf16 v[116:119], a[184:187], v[164:167], v[116:119]
    ds_read_b64_tr_b16 v[148:149], v24 offset:16384
    buffer_load_dwordx4 v15, s[4:7], s61 offen offset:3072 lds
    v_mfma_f32_16x16x32_bf16 v[120:123], a[188:191], v[164:167], v[120:123]
    ds_read_b64_tr_b16 v[150:151], v24 offset:16896
    v_mfma_f32_16x16x32_bf16 v[124:127], a[184:187], v[168:171], v[124:127]
    ds_read_b64_tr_b16 v[152:153], v25 offset:16384
    v_mfma_f32_16x16x32_bf16 v[128:131], a[188:191], v[168:171], v[128:131]
    ds_read_b64_tr_b16 v[154:155], v25 offset:16896
    v_mfma_f32_16x16x32_bf16 v[132:135], a[184:187], v[172:175], v[132:135]
    s_add_u32 m0, s72, 4096
    s_add_u32 s74, s61, s71
    s_nop 0
    buffer_load_dwordx4 v12, s[4:7], s74 offen offset:0 lds
    ds_read_b64_tr_b16 v[156:157], v26 offset:16384
    v_mfma_f32_16x16x32_bf16 v[136:139], a[188:191], v[172:175], v[136:139]
    ds_read_b64_tr_b16 v[158:159], v26 offset:16896
    v_mfma_f32_16x16x32_bf16 v[140:143], a[184:187], v[176:179], v[140:143]
    ds_read_b64_tr_b16 v[160:161], v27 offset:16384
    v_mfma_f32_16x16x32_bf16 v[144:147], a[188:191], v[176:179], v[144:147]
    ds_read_b64_tr_b16 v[162:163], v27 offset:16896
    buffer_load_dwordx4 v13, s[4:7], s74 offen offset:1024 lds
    s_waitcnt lgkmcnt(4)
    v_mfma_f32_16x16x32_bf16 v[116:119], a[192:195], v[148:151], v[116:119]
    ds_read_b64_tr_b16 v[164:165], v24 offset:17408
    s_nop 0
    v_mfma_f32_16x16x32_bf16 v[120:123], a[196:199], v[148:151], v[120:123]
    ds_read_b64_tr_b16 v[166:167], v24 offset:17920
    v_mfma_f32_16x16x32_bf16 v[124:127], a[192:195], v[152:155], v[124:127]
    ds_read_b64_tr_b16 v[168:169], v25 offset:17408
    v_mfma_f32_16x16x32_bf16 v[128:131], a[196:199], v[152:155], v[128:131]
    buffer_load_dwordx4 v14, s[4:7], s74 offen offset:2048 lds
    ds_read_b64_tr_b16 v[170:171], v25 offset:17920
    s_waitcnt lgkmcnt(4)
    s_nop 0
    v_mfma_f32_16x16x32_bf16 v[132:135], a[192:195], v[156:159], v[132:135]
    ds_read_b64_tr_b16 v[172:173], v26 offset:17408
    v_mfma_f32_16x16x32_bf16 v[136:139], a[196:199], v[156:159], v[136:139]
    ds_read_b64_tr_b16 v[174:175], v26 offset:17920
    v_mfma_f32_16x16x32_bf16 v[140:143], a[192:195], v[160:163], v[140:143]
    ds_read_b64_tr_b16 v[176:177], v27 offset:17408
    v_mfma_f32_16x16x32_bf16 v[144:147], a[196:199], v[160:163], v[144:147]
    buffer_load_dwordx4 v15, s[4:7], s74 offen offset:3072 lds
    ds_read_b64_tr_b16 v[178:179], v27 offset:17920
    s_waitcnt lgkmcnt(4)
    v_mfma_f32_16x16x32_bf16 v[116:119], a[200:203], v[164:167], v[116:119]
    ds_read_b64_tr_b16 v[148:149], v24 offset:18432
    s_nop 0
    v_mfma_f32_16x16x32_bf16 v[120:123], a[204:207], v[164:167], v[120:123]
    ds_read_b64_tr_b16 v[150:151], v24 offset:18944
    v_mfma_f32_16x16x32_bf16 v[124:127], a[200:203], v[168:171], v[124:127]
    ds_read_b64_tr_b16 v[152:153], v25 offset:18432
    s_add_u32 m0, s73, 49152
    s_add_u32 s74, s66, 1536
    buffer_load_dwordx4 v20, s[8:11], s74 offen offset:0 lds
    v_mfma_f32_16x16x32_bf16 v[128:131], a[204:207], v[168:171], v[128:131]
    ds_read_b64_tr_b16 v[154:155], v25 offset:18944
    s_waitcnt vmcnt(17)
    ds_read_b128 a[224:227], v8 offset:16384
    ds_read_b128 a[232:235], v9 offset:16384
    s_nop 0
    ds_read_b128 a[240:243], v10 offset:16384
    ds_read_b128 a[248:251], v11 offset:16384
    s_waitcnt lgkmcnt(8)
    v_mfma_f32_16x16x32_bf16 v[132:135], a[200:203], v[172:175], v[132:135]
    s_nop 0
    ds_read_b64_tr_b16 v[156:157], v26 offset:18432
    v_mfma_f32_16x16x32_bf16 v[136:139], a[204:207], v[172:175], v[136:139]
    buffer_load_dwordx4 v21, s[8:11], s74 offen offset:1024 lds
    ds_read_b64_tr_b16 v[158:159], v26 offset:18944
    v_mfma_f32_16x16x32_bf16 v[140:143], a[200:203], v[176:179], v[140:143]
    ds_read_b64_tr_b16 v[160:161], v27 offset:18432
    v_mfma_f32_16x16x32_bf16 v[144:147], a[204:207], v[176:179], v[144:147]
    ds_read_b64_tr_b16 v[162:163], v27 offset:18944
    s_waitcnt lgkmcnt(8)
    v_mfma_f32_16x16x32_bf16 v[116:119], a[208:211], v[148:151], v[116:119]
    ds_read_b64_tr_b16 v[164:165], v24 offset:19456
    buffer_load_dwordx4 v22, s[8:11], s74 offen offset:2048 lds
    s_nop 0
    v_mfma_f32_16x16x32_bf16 v[120:123], a[212:215], v[148:151], v[120:123]
    ds_read_b64_tr_b16 v[166:167], v24 offset:19968
    v_mfma_f32_16x16x32_bf16 v[124:127], a[208:211], v[152:155], v[124:127]
    ds_read_b64_tr_b16 v[168:169], v25 offset:19456
    v_mfma_f32_16x16x32_bf16 v[128:131], a[212:215], v[152:155], v[128:131]
    ds_read_b64_tr_b16 v[170:171], v25 offset:19968
    s_waitcnt lgkmcnt(4)
    v_mfma_f32_16x16x32_bf16 v[132:135], a[208:211], v[156:159], v[132:135]
    s_nop 0
    buffer_load_dwordx4 v23, s[8:11], s74 offen offset:3072 lds
    ds_read_b64_tr_b16 v[172:173], v26 offset:19456
    v_mfma_f32_16x16x32_bf16 v[136:139], a[212:215], v[156:159], v[136:139]
    ds_read_b64_tr_b16 v[174:175], v26 offset:19968
    v_mfma_f32_16x16x32_bf16 v[140:143], a[208:211], v[160:163], v[140:143]
    ds_read_b64_tr_b16 v[176:177], v27 offset:19456
    v_mfma_f32_16x16x32_bf16 v[144:147], a[212:215], v[160:163], v[144:147]
    ds_read_b64_tr_b16 v[178:179], v27 offset:19968
    s_mov_b32 s24, 0x3827c5ac
    s_mov_b32 s28, 0xaaaaaaaa
    v_bfe_u32 v252, v43, 0, 8
    s_mov_b32 s25, 0x3daaaaab
    s_mov_b32 s29, 0xaaaaaaaa
    v_bfe_u32 v253, v43, 8, 8
    s_mov_b32 s26, 0x41ddb3d7
    s_mov_b32 s30, 0xcccccccc
    v_bfe_u32 v254, v43, 16, 8
    s_mov_b32 s27, 0x3e93cd3a
    s_mov_b32 s31, 0xcccccccc
    v_bfe_u32 v255, v43, 24, 8
    s_waitcnt vmcnt(16)
    ds_read_b128 a[228:231], v8 offset:20480
    ds_read_b128 a[236:239], v9 offset:20480
    ds_read_b128 a[244:247], v10 offset:20480
    s_nop 0
    ds_read_b128 a[252:255], v11 offset:20480
    s_add_u32 m0, s72, 8192
    s_nop 0
    buffer_load_dwordx4 v12, s[4:7], s62 offen offset:0 lds
    s_nop 0
    buffer_load_dwordx4 v13, s[4:7], s62 offen offset:1024 lds
    s_waitcnt vmcnt(14)
    s_waitcnt lgkmcnt(4)
    s_barrier
    v_mfma_f32_16x16x32_bf16 v[116:119], a[216:219], v[164:167], v[116:119]
    s_nop 0
    ds_read_b64_tr_b16 v[148:149], v24 offset:32768
    buffer_load_dwordx4 v14, s[4:7], s62 offen offset:2048 lds
    v_mfma_f32_16x16x32_bf16 v[120:123], a[220:223], v[164:167], v[120:123]
    ds_read_b64_tr_b16 v[150:151], v24 offset:33280
    v_mfma_f32_16x16x32_bf16 v[124:127], a[216:219], v[168:171], v[124:127]
    ds_read_b64_tr_b16 v[152:153], v25 offset:32768
    v_mfma_f32_16x16x32_bf16 v[128:131], a[220:223], v[168:171], v[128:131]
    ds_read_b64_tr_b16 v[154:155], v25 offset:33280
    v_mfma_f32_16x16x32_bf16 v[132:135], a[216:219], v[172:175], v[132:135]
    buffer_load_dwordx4 v15, s[4:7], s62 offen offset:3072 lds
    ds_read_b64_tr_b16 v[156:157], v26 offset:32768
    v_mfma_f32_16x16x32_bf16 v[136:139], a[220:223], v[172:175], v[136:139]
    ds_read_b64_tr_b16 v[158:159], v26 offset:33280
    v_mfma_f32_16x16x32_bf16 v[140:143], a[216:219], v[176:179], v[140:143]
    ds_read_b64_tr_b16 v[160:161], v27 offset:32768
    v_mfma_f32_16x16x32_bf16 v[144:147], a[220:223], v[176:179], v[144:147]
    ds_read_b64_tr_b16 v[162:163], v27 offset:33280
    s_waitcnt lgkmcnt(4)
    v_mfma_f32_16x16x32_bf16 v[116:119], a[224:227], v[148:151], v[116:119]
    s_add_u32 m0, s72, 12288
    s_add_u32 s74, s62, s71
    buffer_load_dwordx4 v12, s[4:7], s74 offen offset:0 lds
    ds_read_b64_tr_b16 v[164:165], v24 offset:33792
    v_mfma_f32_16x16x32_bf16 v[120:123], a[228:231], v[148:151], v[120:123]
    ds_read_b64_tr_b16 v[166:167], v24 offset:34304
    v_mfma_f32_16x16x32_bf16 v[124:127], a[224:227], v[152:155], v[124:127]
    ds_read_b64_tr_b16 v[168:169], v25 offset:33792
    v_mfma_f32_16x16x32_bf16 v[128:131], a[228:231], v[152:155], v[128:131]
    buffer_load_dwordx4 v13, s[4:7], s74 offen offset:1024 lds
    ds_read_b64_tr_b16 v[170:171], v25 offset:34304
    s_waitcnt lgkmcnt(4)
    v_mfma_f32_16x16x32_bf16 v[132:135], a[224:227], v[156:159], v[132:135]
    ds_read_b64_tr_b16 v[172:173], v26 offset:33792
    s_nop 0
    v_mfma_f32_16x16x32_bf16 v[136:139], a[228:231], v[156:159], v[136:139]
    ds_read_b64_tr_b16 v[174:175], v26 offset:34304
    v_mfma_f32_16x16x32_bf16 v[140:143], a[224:227], v[160:163], v[140:143]
    ds_read_b64_tr_b16 v[176:177], v27 offset:33792
    v_mfma_f32_16x16x32_bf16 v[144:147], a[228:231], v[160:163], v[144:147]
    buffer_load_dwordx4 v14, s[4:7], s74 offen offset:2048 lds
    ds_read_b64_tr_b16 v[178:179], v27 offset:34304
    s_waitcnt lgkmcnt(4)
    s_nop 0
    v_mfma_f32_16x16x32_bf16 v[116:119], a[232:235], v[164:167], v[116:119]
    ds_read_b64_tr_b16 v[148:149], v24 offset:34816
    v_mfma_f32_16x16x32_bf16 v[120:123], a[236:239], v[164:167], v[120:123]
    ds_read_b64_tr_b16 v[150:151], v24 offset:35328
    v_mfma_f32_16x16x32_bf16 v[124:127], a[232:235], v[168:171], v[124:127]
    ds_read_b64_tr_b16 v[152:153], v25 offset:34816
    buffer_load_dwordx4 v15, s[4:7], s74 offen offset:3072 lds
    v_mfma_f32_16x16x32_bf16 v[128:131], a[236:239], v[168:171], v[128:131]
    ds_read_b64_tr_b16 v[154:155], v25 offset:35328
    s_waitcnt vmcnt(16)
    ds_read_b128 v[52:55], v8 offset:0
    ds_read_b128 v[60:63], v9 offset:0
    s_nop 0
    ds_read_b128 v[68:71], v10 offset:0
    ds_read_b128 v[76:79], v11 offset:0
    s_waitcnt lgkmcnt(8)
    v_mfma_f32_16x16x32_bf16 v[132:135], a[232:235], v[172:175], v[132:135]
    s_nop 0
    ds_read_b64_tr_b16 v[156:157], v26 offset:34816
    v_mfma_f32_16x16x32_bf16 v[136:139], a[236:239], v[172:175], v[136:139]
    s_add_u32 m0, s73, 0
    s_add_u32 s74, s67, 1536
    s_nop 0
    buffer_load_dwordx4 v20, s[8:11], s74 offen offset:0 lds
    ds_read_b64_tr_b16 v[158:159], v26 offset:35328
    v_mfma_f32_16x16x32_bf16 v[140:143], a[232:235], v[176:179], v[140:143]
    ds_read_b64_tr_b16 v[160:161], v27 offset:34816
    v_mfma_f32_16x16x32_bf16 v[144:147], a[236:239], v[176:179], v[144:147]
    ds_read_b64_tr_b16 v[162:163], v27 offset:35328
    s_waitcnt lgkmcnt(8)
    v_mfma_f32_16x16x32_bf16 v[116:119], a[240:243], v[148:151], v[116:119]
    s_nop 0
    ds_read_b64_tr_b16 v[164:165], v24 offset:35840
    buffer_load_dwordx4 v21, s[8:11], s74 offen offset:1024 lds
    v_mfma_f32_16x16x32_bf16 v[120:123], a[244:247], v[148:151], v[120:123]
    ds_read_b64_tr_b16 v[166:167], v24 offset:36352
    v_mfma_f32_16x16x32_bf16 v[124:127], a[240:243], v[152:155], v[124:127]
    ds_read_b64_tr_b16 v[168:169], v25 offset:35840
    v_mfma_f32_16x16x32_bf16 v[128:131], a[244:247], v[152:155], v[128:131]
    ds_read_b64_tr_b16 v[170:171], v25 offset:36352
    s_waitcnt lgkmcnt(4)
    v_mfma_f32_16x16x32_bf16 v[132:135], a[240:243], v[156:159], v[132:135]
    buffer_load_dwordx4 v22, s[8:11], s74 offen offset:2048 lds
    ds_read_b64_tr_b16 v[172:173], v26 offset:35840
    s_nop 0
    v_mfma_f32_16x16x32_bf16 v[136:139], a[244:247], v[156:159], v[136:139]
    ds_read_b64_tr_b16 v[174:175], v26 offset:36352
    v_mfma_f32_16x16x32_bf16 v[140:143], a[240:243], v[160:163], v[140:143]
    ds_read_b64_tr_b16 v[176:177], v27 offset:35840
    v_mfma_f32_16x16x32_bf16 v[144:147], a[244:247], v[160:163], v[144:147]
    ds_read_b64_tr_b16 v[178:179], v27 offset:36352
    buffer_load_dwordx4 v23, s[8:11], s74 offen offset:3072 lds
    s_waitcnt vmcnt(16)
    s_nop 0
    ds_read_b128 v[56:59], v8 offset:4096
    ds_read_b128 v[64:67], v9 offset:4096
    ds_read_b128 v[72:75], v10 offset:4096
    ds_read_b128 v[80:83], v11 offset:4096
    s_waitcnt vmcnt(12)
    s_add_u32 m0, s73, 16384
    s_nop 0
    buffer_load_dwordx4 v20, s[8:11], s63 offen offset:0 lds
    s_waitcnt lgkmcnt(4)
    s_barrier
    v_mfma_f32_16x16x32_bf16 v[116:119], a[248:251], v[164:167], v[116:119]
    ds_read_b64_tr_b16 v[148:149], v24 offset:49152
    v_mfma_f32_16x16x32_bf16 v[120:123], a[252:255], v[164:167], v[120:123]
    buffer_load_dwordx4 v21, s[8:11], s63 offen offset:1024 lds
    ds_read_b64_tr_b16 v[150:151], v24 offset:49664
    v_mfma_f32_16x16x32_bf16 v[124:127], a[248:251], v[168:171], v[124:127]
    ds_read_b64_tr_b16 v[152:153], v25 offset:49152
    v_mfma_f32_16x16x32_bf16 v[128:131], a[252:255], v[168:171], v[128:131]
    ds_read_b64_tr_b16 v[154:155], v25 offset:49664
    v_mfma_f32_16x16x32_bf16 v[132:135], a[248:251], v[172:175], v[132:135]
    ds_read_b64_tr_b16 v[156:157], v26 offset:49152
    v_mfma_f32_16x16x32_bf16 v[136:139], a[252:255], v[172:175], v[136:139]
    buffer_load_dwordx4 v22, s[8:11], s63 offen offset:2048 lds
    ds_read_b64_tr_b16 v[158:159], v26 offset:49664
    v_mfma_f32_16x16x32_bf16 v[140:143], a[248:251], v[176:179], v[140:143]
    ds_read_b64_tr_b16 v[160:161], v27 offset:49152
    v_mfma_f32_16x16x32_bf16 v[144:147], a[252:255], v[176:179], v[144:147]
    ds_read_b64_tr_b16 v[162:163], v27 offset:49664
    s_waitcnt lgkmcnt(4)
    v_mfma_f32_16x16x32_bf16 v[116:119], v[52:55], v[148:151], v[116:119]
    s_nop 0
    buffer_load_dwordx4 v23, s[8:11], s63 offen offset:3072 lds
    ds_read_b64_tr_b16 v[164:165], v24 offset:50176
    v_mfma_f32_16x16x32_bf16 v[120:123], v[56:59], v[148:151], v[120:123]
    ds_read_b64_tr_b16 v[166:167], v24 offset:50688
    v_mfma_f32_16x16x32_bf16 v[124:127], v[52:55], v[152:155], v[124:127]
    ds_read_b64_tr_b16 v[168:169], v25 offset:50176
    v_mfma_f32_16x16x32_bf16 v[128:131], v[56:59], v[152:155], v[128:131]
    ds_read_b64_tr_b16 v[170:171], v25 offset:50688
    s_add_u32 m0, s72, 16384
    s_add_u32 s74, s32, s36
    buffer_load_dwordx4 v16, s[12:15], s74 offen offset:0 lds
    s_waitcnt lgkmcnt(4)
    v_mfma_f32_16x16x32_bf16 v[132:135], v[52:55], v[156:159], v[132:135]
    ds_read_b64_tr_b16 v[172:173], v26 offset:50176
    v_mfma_f32_16x16x32_bf16 v[136:139], v[56:59], v[156:159], v[136:139]
    ds_read_b64_tr_b16 v[174:175], v26 offset:50688
    v_mfma_f32_16x16x32_bf16 v[140:143], v[52:55], v[160:163], v[140:143]
    buffer_load_dwordx4 v17, s[12:15], s74 offen offset:1024 lds
    ds_read_b64_tr_b16 v[176:177], v27 offset:50176
    v_mfma_f32_16x16x32_bf16 v[144:147], v[56:59], v[160:163], v[144:147]
    ds_read_b64_tr_b16 v[178:179], v27 offset:50688
    s_waitcnt lgkmcnt(4)
    v_mfma_f32_16x16x32_bf16 v[116:119], v[60:63], v[164:167], v[116:119]
    ds_read_b64_tr_b16 v[148:149], v24 offset:51200
    v_mfma_f32_16x16x32_bf16 v[120:123], v[64:67], v[164:167], v[120:123]
    s_nop 0
    buffer_load_dwordx4 v18, s[12:15], s74 offen offset:2048 lds
    ds_read_b64_tr_b16 v[150:151], v24 offset:51712
    v_mfma_f32_16x16x32_bf16 v[124:127], v[60:63], v[168:171], v[124:127]
    ds_read_b64_tr_b16 v[152:153], v25 offset:51200
    v_mfma_f32_16x16x32_bf16 v[128:131], v[64:67], v[168:171], v[128:131]
    ds_read_b64_tr_b16 v[154:155], v25 offset:51712
    s_waitcnt lgkmcnt(4)
    v_mfma_f32_16x16x32_bf16 v[132:135], v[60:63], v[172:175], v[132:135]
    s_nop 0
    ds_read_b64_tr_b16 v[156:157], v26 offset:51200
    buffer_load_dwordx4 v19, s[12:15], s74 offen offset:3072 lds
    s_waitcnt vmcnt(16)
    ds_read_b128 v[84:87], v8 offset:8192
    s_nop 0
    ds_read_b128 v[92:95], v9 offset:8192
    ds_read_b128 v[100:103], v10 offset:8192
    ds_read_b128 v[108:111], v11 offset:8192
    v_mfma_f32_16x16x32_bf16 v[136:139], v[64:67], v[172:175], v[136:139]
    ds_read_b64_tr_b16 v[158:159], v26 offset:51712
    v_mfma_f32_16x16x32_bf16 v[140:143], v[60:63], v[176:179], v[140:143]
    ds_read_b64_tr_b16 v[160:161], v27 offset:51200
    v_mfma_f32_16x16x32_bf16 v[144:147], v[64:67], v[176:179], v[144:147]
    s_add_u32 m0, s72, 20480
    s_add_u32 s74, s32, s37
    buffer_load_dwordx4 v16, s[12:15], s74 offen offset:0 lds
    ds_read_b64_tr_b16 v[162:163], v27 offset:51712
    s_waitcnt lgkmcnt(8)
    v_mfma_f32_16x16x32_bf16 v[116:119], v[68:71], v[148:151], v[116:119]
    ds_read_b64_tr_b16 v[164:165], v24 offset:52224
    v_mfma_f32_16x16x32_bf16 v[120:123], v[72:75], v[148:151], v[120:123]
    ds_read_b64_tr_b16 v[166:167], v24 offset:52736
    buffer_load_dwordx4 v17, s[12:15], s74 offen offset:1024 lds
    v_mfma_f32_16x16x32_bf16 v[124:127], v[68:71], v[152:155], v[124:127]
    ds_read_b64_tr_b16 v[168:169], v25 offset:52224
    v_mfma_f32_16x16x32_bf16 v[128:131], v[72:75], v[152:155], v[128:131]
    ds_read_b64_tr_b16 v[170:171], v25 offset:52736
    s_waitcnt lgkmcnt(4)
    v_mfma_f32_16x16x32_bf16 v[132:135], v[68:71], v[156:159], v[132:135]
    ds_read_b64_tr_b16 v[172:173], v26 offset:52224
    s_nop 0
    v_mfma_f32_16x16x32_bf16 v[136:139], v[72:75], v[156:159], v[136:139]
    buffer_load_dwordx4 v18, s[12:15], s74 offen offset:2048 lds
    ds_read_b64_tr_b16 v[174:175], v26 offset:52736
    v_mfma_f32_16x16x32_bf16 v[140:143], v[68:71], v[160:163], v[140:143]
    ds_read_b64_tr_b16 v[176:177], v27 offset:52224
    v_mfma_f32_16x16x32_bf16 v[144:147], v[72:75], v[160:163], v[144:147]
    ds_read_b64_tr_b16 v[178:179], v27 offset:52736
    buffer_load_dwordx4 v19, s[12:15], s74 offen offset:3072 lds
    s_waitcnt vmcnt(16)
    ds_read_b128 v[88:91], v8 offset:12288
    ds_read_b128 v[96:99], v9 offset:12288
    ds_read_b128 v[104:107], v10 offset:12288
    s_nop 0
    ds_read_b128 v[112:115], v11 offset:12288
    s_waitcnt vmcnt(12)
    s_waitcnt lgkmcnt(4)
    s_barrier
    s_add_u32 m0, s73, 32768
    s_nop 0
    buffer_load_dwordx4 v20, s[8:11], s64 offen offset:0 lds
    v_mfma_f32_16x16x32_bf16 v[116:119], v[76:79], v[164:167], v[116:119]
    ds_read_b64_tr_b16 v[148:149], v24 offset:0
    v_mfma_f32_16x16x32_bf16 v[120:123], v[80:83], v[164:167], v[120:123]
    ds_read_b64_tr_b16 v[150:151], v24 offset:512
    v_mfma_f32_16x16x32_bf16 v[124:127], v[76:79], v[168:171], v[124:127]
    ds_read_b64_tr_b16 v[152:153], v25 offset:0
    v_mfma_f32_16x16x32_bf16 v[128:131], v[80:83], v[168:171], v[128:131]
    ds_read_b64_tr_b16 v[154:155], v25 offset:512
    v_mfma_f32_16x16x32_bf16 v[132:135], v[76:79], v[172:175], v[132:135]
    buffer_load_dwordx4 v21, s[8:11], s64 offen offset:1024 lds
    v_mov_b32 v248, -1
    v_mov_b32 v249, -1
    v_mov_b32 v250, -1
    v_mov_b32 v251, -1
    ds_read_b64_tr_b16 v[156:157], v26 offset:0
    v_mfma_f32_16x16x32_bf16 v[136:139], v[80:83], v[172:175], v[136:139]
    ds_read_b64_tr_b16 v[158:159], v26 offset:512
    v_mfma_f32_16x16x32_bf16 v[140:143], v[76:79], v[176:179], v[140:143]
    ds_read_b64_tr_b16 v[160:161], v27 offset:0
    v_mfma_f32_16x16x32_bf16 v[144:147], v[80:83], v[176:179], v[144:147]
    ds_read_b64_tr_b16 v[162:163], v27 offset:512
    s_waitcnt lgkmcnt(4)
    v_mfma_f32_16x16x32_bf16 v[116:119], v[84:87], v[148:151], v[116:119]
    s_add_u32 s70, s78, 0
    buffer_store_dwordx4 v[248:251], v2, s[16:19], s70 offen sc1
    ds_read_b64_tr_b16 v[164:165], v24 offset:1024
    v_mfma_f32_16x16x32_bf16 v[120:123], v[88:91], v[148:151], v[120:123]
    ds_read_b64_tr_b16 v[166:167], v24 offset:1536
    v_mfma_f32_16x16x32_bf16 v[124:127], v[84:87], v[152:155], v[124:127]
    ds_read_b64_tr_b16 v[168:169], v25 offset:1024
    v_mfma_f32_16x16x32_bf16 v[128:131], v[88:91], v[152:155], v[128:131]
    ds_read_b64_tr_b16 v[170:171], v25 offset:1536
    s_waitcnt lgkmcnt(4)
    v_mfma_f32_16x16x32_bf16 v[132:135], v[84:87], v[156:159], v[132:135]
    s_nop 0
    ds_read_b64_tr_b16 v[172:173], v26 offset:1024
    v_mfma_f32_16x16x32_bf16 v[136:139], v[88:91], v[156:159], v[136:139]
    s_add_u32 s70, s78, 32768
    buffer_store_dwordx4 v[248:251], v2, s[16:19], s70 offen sc1
    ds_read_b64_tr_b16 v[174:175], v26 offset:1536
    v_mfma_f32_16x16x32_bf16 v[140:143], v[84:87], v[160:163], v[140:143]
    ds_read_b64_tr_b16 v[176:177], v27 offset:1024
    v_mfma_f32_16x16x32_bf16 v[144:147], v[88:91], v[160:163], v[144:147]
    ds_read_b64_tr_b16 v[178:179], v27 offset:1536
    s_waitcnt lgkmcnt(4)
    v_mfma_f32_16x16x32_bf16 v[116:119], v[92:95], v[164:167], v[116:119]
    ds_read_b64_tr_b16 v[148:149], v24 offset:2048
    s_nop 0
    v_mfma_f32_16x16x32_bf16 v[120:123], v[96:99], v[164:167], v[120:123]
    ds_read_b64_tr_b16 v[150:151], v24 offset:2560
    v_mfma_f32_16x16x32_bf16 v[124:127], v[92:95], v[168:171], v[124:127]
    s_add_u32 s70, s78, 65536
    buffer_store_dwordx4 v[248:251], v2, s[16:19], s70 offen sc1
    ds_read_b64_tr_b16 v[152:153], v25 offset:2048
    v_mfma_f32_16x16x32_bf16 v[128:131], v[96:99], v[168:171], v[128:131]
    ds_read_b64_tr_b16 v[154:155], v25 offset:2560
    s_waitcnt lgkmcnt(4)
    v_mfma_f32_16x16x32_bf16 v[132:135], v[92:95], v[172:175], v[132:135]
    ds_read_b64_tr_b16 v[156:157], v26 offset:2048
    v_mfma_f32_16x16x32_bf16 v[136:139], v[96:99], v[172:175], v[136:139]
    s_nop 0
    ds_read_b64_tr_b16 v[158:159], v26 offset:2560
    v_mfma_f32_16x16x32_bf16 v[140:143], v[92:95], v[176:179], v[140:143]
    ds_read_b64_tr_b16 v[160:161], v27 offset:2048
    v_mfma_f32_16x16x32_bf16 v[144:147], v[96:99], v[176:179], v[144:147]
    buffer_load_dwordx4 v22, s[8:11], s64 offen offset:2048 lds
    ds_read_b64_tr_b16 v[162:163], v27 offset:2560
    s_waitcnt lgkmcnt(4)
    v_mfma_f32_16x16x32_bf16 v[116:119], v[100:103], v[148:151], v[116:119]
    s_nop 0
    ds_read_b64_tr_b16 v[164:165], v24 offset:3072
    v_mfma_f32_16x16x32_bf16 v[120:123], v[104:107], v[148:151], v[120:123]
    ds_read_b64_tr_b16 v[166:167], v24 offset:3584
    v_mfma_f32_16x16x32_bf16 v[124:127], v[100:103], v[152:155], v[124:127]
    ds_read_b64_tr_b16 v[168:169], v25 offset:3072
    v_mfma_f32_16x16x32_bf16 v[128:131], v[104:107], v[152:155], v[128:131]
    ds_read_b64_tr_b16 v[170:171], v25 offset:3584
    s_waitcnt lgkmcnt(4)
    s_nop 0
    v_mfma_f32_16x16x32_bf16 v[132:135], v[100:103], v[156:159], v[132:135]
    buffer_load_dwordx4 v23, s[8:11], s64 offen offset:3072 lds
    ds_read_b64_tr_b16 v[172:173], v26 offset:3072
    v_mfma_f32_16x16x32_bf16 v[136:139], v[104:107], v[156:159], v[136:139]
    ds_read_b64_tr_b16 v[174:175], v26 offset:3584
    v_mfma_f32_16x16x32_bf16 v[140:143], v[100:103], v[160:163], v[140:143]
    ds_read_b64_tr_b16 v[176:177], v27 offset:3072
    v_mfma_f32_16x16x32_bf16 v[144:147], v[104:107], v[160:163], v[144:147]
    ds_read_b64_tr_b16 v[178:179], v27 offset:3584
    s_waitcnt lgkmcnt(4)
    v_mfma_f32_16x16x32_bf16 v[116:119], v[108:111], v[164:167], v[116:119]
    v_mfma_f32_16x16x32_bf16 v[120:123], v[112:115], v[164:167], v[120:123]
    s_nop 0
    v_mfma_f32_16x16x32_bf16 v[124:127], v[108:111], v[168:171], v[124:127]
    v_mfma_f32_16x16x32_bf16 v[128:131], v[112:115], v[168:171], v[128:131]
    s_waitcnt vmcnt(11)
    ds_read_b128 a[0:3], v8 offset:16384
    s_nop 0
    ds_read_b128 a[4:7], v9 offset:16384
    ds_read_b128 a[8:11], v10 offset:16384
    ds_read_b128 a[12:15], v11 offset:16384
    s_add_u32 m0, s72, 0
    s_add_u32 s74, s32, s38
    buffer_load_dwordx4 v16, s[12:15], s74 offen offset:0 lds
    s_waitcnt lgkmcnt(4)
    v_mfma_f32_16x16x32_bf16 v[132:135], v[108:111], v[172:175], v[132:135]
    v_mfma_f32_16x16x32_bf16 v[136:139], v[112:115], v[172:175], v[136:139]
    s_nop 0
    v_mfma_f32_16x16x32_bf16 v[140:143], v[108:111], v[176:179], v[140:143]
    v_mfma_f32_16x16x32_bf16 v[144:147], v[112:115], v[176:179], v[144:147]
    v_pk_mul_f32 v[212:213], v[116:117], v[116:117]
    buffer_load_dwordx4 v17, s[12:15], s74 offen offset:1024 lds
    v_pk_mul_f32 v[214:215], v[118:119], v[118:119]
    v_pk_mul_f32 v[216:217], v[120:121], v[120:121]
    v_pk_mul_f32 v[218:219], v[122:123], v[122:123]
    v_pk_fma_f32 v[212:213], v[212:213], s[68:69], v[36:37]
    v_pk_fma_f32 v[214:215], v[214:215], s[68:69], v[36:37]
    v_pk_fma_f32 v[216:217], v[216:217], s[68:69], v[36:37]
    v_pk_fma_f32 v[218:219], v[218:219], s[68:69], v[36:37]
    v_pk_mul_f32 v[212:213], v[212:213], v[116:117]
    v_pk_mul_f32 v[214:215], v[214:215], v[118:119]
    v_pk_mul_f32 v[216:217], v[216:217], v[120:121]
    v_pk_mul_f32 v[218:219], v[218:219], v[122:123]
    v_exp_f32 v212, v212
    v_exp_f32 v213, v213
    v_exp_f32 v214, v214
    buffer_load_dwordx4 v18, s[12:15], s74 offen offset:2048 lds
    v_exp_f32 v215, v215
    v_exp_f32 v216, v216
    v_exp_f32 v217, v217
    v_exp_f32 v218, v218
    v_exp_f32 v219, v219
    v_pk_add_f32 v[212:213], v[212:213], 1.0 op_sel_hi:[1,0]
    s_waitcnt vmcnt(10)
    ds_read_b128 a[16:19], v8 offset:20480
    ds_read_b128 a[20:23], v9 offset:20480
    s_nop 0
    ds_read_b128 a[24:27], v10 offset:20480
    ds_read_b128 a[28:31], v11 offset:20480
    v_pk_add_f32 v[214:215], v[214:215], 1.0 op_sel_hi:[1,0]
    v_pk_add_f32 v[216:217], v[216:217], 1.0 op_sel_hi:[1,0]
    buffer_load_dwordx4 v19, s[12:15], s74 offen offset:3072 lds
    v_pk_add_f32 v[218:219], v[218:219], 1.0 op_sel_hi:[1,0]
    v_rcp_f32 v212, v212
    v_rcp_f32 v213, v213
    v_rcp_f32 v214, v214
    v_rcp_f32 v215, v215
    v_rcp_f32 v216, v216
    v_rcp_f32 v217, v217
    v_rcp_f32 v218, v218
    v_rcp_f32 v219, v219
    v_pk_mul_f32 v[116:117], v[116:117], v[212:213]
    s_add_u32 m0, s73, 49152
    s_nop 0
    buffer_load_dwordx4 v20, s[8:11], s65 offen offset:0 lds
    v_pk_mul_f32 v[118:119], v[118:119], v[214:215]
    v_pk_mul_f32 v[120:121], v[120:121], v[216:217]
    s_nop 0
    v_pk_mul_f32 v[122:123], v[122:123], v[218:219]
    v_pk_mul_f32 v[212:213], v[124:125], v[124:125]
    v_pk_mul_f32 v[214:215], v[126:127], v[126:127]
    v_pk_mul_f32 v[216:217], v[128:129], v[128:129]
    v_pk_mul_f32 v[218:219], v[130:131], v[130:131]
    v_pk_fma_f32 v[212:213], v[212:213], s[68:69], v[36:37]
    v_pk_fma_f32 v[214:215], v[214:215], s[68:69], v[36:37]
    v_pk_fma_f32 v[216:217], v[216:217], s[68:69], v[36:37]
    v_pk_fma_f32 v[218:219], v[218:219], s[68:69], v[36:37]
    v_pk_mul_f32 v[212:213], v[212:213], v[124:125]
    v_pk_mul_f32 v[214:215], v[214:215], v[126:127]
    v_pk_mul_f32 v[216:217], v[216:217], v[128:129]
    v_pk_mul_f32 v[218:219], v[218:219], v[130:131]
    v_exp_f32 v212, v212
    v_exp_f32 v213, v213
    buffer_load_dwordx4 v21, s[8:11], s65 offen offset:1024 lds
    v_exp_f32 v214, v214
    v_exp_f32 v215, v215
    v_exp_f32 v216, v216
    v_exp_f32 v217, v217
    v_exp_f32 v218, v218
    v_exp_f32 v219, v219
    v_pk_add_f32 v[212:213], v[212:213], 1.0 op_sel_hi:[1,0]
    v_pk_add_f32 v[214:215], v[214:215], 1.0 op_sel_hi:[1,0]
    v_pk_add_f32 v[216:217], v[216:217], 1.0 op_sel_hi:[1,0]
    v_pk_add_f32 v[218:219], v[218:219], 1.0 op_sel_hi:[1,0]
    v_rcp_f32 v212, v212
    buffer_load_dwordx4 v22, s[8:11], s65 offen offset:2048 lds
    v_rcp_f32 v213, v213
    v_rcp_f32 v214, v214
    v_rcp_f32 v215, v215
    v_rcp_f32 v216, v216
    v_rcp_f32 v217, v217
    v_rcp_f32 v218, v218
    v_rcp_f32 v219, v219
    v_pk_mul_f32 v[124:125], v[124:125], v[212:213]
    v_pk_mul_f32 v[126:127], v[126:127], v[214:215]
    v_pk_mul_f32 v[128:129], v[128:129], v[216:217]
    v_pk_mul_f32 v[130:131], v[130:131], v[218:219]
    buffer_load_dwordx4 v23, s[8:11], s65 offen offset:3072 lds
    v_pk_mul_f32 v[212:213], v[132:133], v[132:133]
    v_pk_mul_f32 v[214:215], v[134:135], v[134:135]
    v_pk_mul_f32 v[216:217], v[136:137], v[136:137]
    v_pk_mul_f32 v[218:219], v[138:139], v[138:139]
    v_pk_fma_f32 v[212:213], v[212:213], s[68:69], v[36:37]
    v_pk_fma_f32 v[214:215], v[214:215], s[68:69], v[36:37]
    v_pk_fma_f32 v[216:217], v[216:217], s[68:69], v[36:37]
    v_pk_fma_f32 v[218:219], v[218:219], s[68:69], v[36:37]
    v_pk_mul_f32 v[212:213], v[212:213], v[132:133]
    v_pk_mul_f32 v[214:215], v[214:215], v[134:135]
    v_pk_mul_f32 v[216:217], v[216:217], v[136:137]
    v_pk_mul_f32 v[218:219], v[218:219], v[138:139]
    v_exp_f32 v212, v212
    v_exp_f32 v213, v213
    v_exp_f32 v214, v214
    s_add_u32 m0, s72, 4096
    s_add_u32 s74, s32, s39
    buffer_load_dwordx4 v16, s[12:15], s74 offen offset:0 lds
    v_exp_f32 v215, v215
    v_exp_f32 v216, v216
    v_exp_f32 v217, v217
    v_exp_f32 v218, v218
    v_exp_f32_e64 v219, v219
    v_pk_add_f32 v[212:213], v[212:213], 1.0 op_sel_hi:[1,0]
    v_pk_add_f32 v[214:215], v[214:215], 1.0 op_sel_hi:[1,0]
    v_pk_add_f32 v[216:217], v[216:217], 1.0 op_sel_hi:[1,0]
    v_pk_add_f32 v[218:219], v[218:219], 1.0 op_sel_hi:[1,0]
    v_rcp_f32 v212, v212
    v_rcp_f32 v213, v213
    buffer_load_dwordx4 v17, s[12:15], s74 offen offset:1024 lds
    v_rcp_f32 v214, v214
    v_rcp_f32 v215, v215
    v_rcp_f32 v216, v216
    v_rcp_f32 v217, v217
    v_rcp_f32 v218, v218
    v_rcp_f32 v219, v219
    v_pk_mul_f32 v[132:133], v[132:133], v[212:213]
    v_pk_mul_f32 v[134:135], v[134:135], v[214:215]
    v_pk_mul_f32 v[136:137], v[136:137], v[216:217]
    v_pk_mul_f32 v[138:139], v[138:139], v[218:219]
    v_pk_mul_f32 v[212:213], v[140:141], v[140:141]
    v_pk_mul_f32 v[214:215], v[142:143], v[142:143]
    buffer_load_dwordx4 v18, s[12:15], s74 offen offset:2048 lds
    v_pk_mul_f32 v[216:217], v[144:145], v[144:145]
    v_pk_mul_f32 v[218:219], v[146:147], v[146:147]
    v_pk_fma_f32 v[212:213], v[212:213], s[68:69], v[36:37]
    v_pk_fma_f32 v[214:215], v[214:215], s[68:69], v[36:37]
    v_pk_fma_f32 v[216:217], v[216:217], s[68:69], v[36:37]
    v_pk_fma_f32 v[218:219], v[218:219], s[68:69], v[36:37]
    v_pk_mul_f32 v[212:213], v[212:213], v[140:141]
    v_pk_mul_f32 v[214:215], v[214:215], v[142:143]
    v_pk_mul_f32 v[216:217], v[216:217], v[144:145]
    v_pk_mul_f32 v[218:219], v[218:219], v[146:147]
    v_exp_f32 v212, v212
    v_exp_f32 v213, v213
    v_exp_f32 v214, v214
    v_exp_f32 v215, v215
    buffer_load_dwordx4 v19, s[12:15], s74 offen offset:3072 lds
    v_exp_f32 v216, v216
    v_exp_f32 v217, v217
    v_exp_f32 v218, v218
    v_exp_f32 v219, v219
    v_pk_add_f32 v[212:213], v[212:213], 1.0 op_sel_hi:[1,0]
    v_pk_add_f32 v[214:215], v[214:215], 1.0 op_sel_hi:[1,0]
    v_pk_add_f32 v[216:217], v[216:217], 1.0 op_sel_hi:[1,0]
    v_pk_add_f32 v[218:219], v[218:219], 1.0 op_sel_hi:[1,0]
    v_rcp_f32 v212, v212
    v_rcp_f32 v213, v213
    v_rcp_f32_e64 v214, v214
    s_add_u32 m0, s72, 8192
    s_add_u32 s74, s33, s36
    buffer_load_dwordx4 v16, s[12:15], s74 offen offset:0 lds
    v_rcp_f32 v215, v215
    v_rcp_f32 v216, v216
    v_rcp_f32 v217, v217
    v_rcp_f32 v218, v218
    v_rcp_f32 v219, v219
    v_pk_mul_f32 v[140:141], v[140:141], v[212:213]
    v_pk_mul_f32 v[142:143], v[142:143], v[214:215]
    v_pk_mul_f32 v[144:145], v[144:145], v[216:217]
    v_pk_mul_f32 v[146:147], v[146:147], v[218:219]
    v_pk_add_f32 v[220:221], v[116:117], v[124:125]
    v_pk_fma_f32 v[228:229], v[116:117], v[116:117], s[24:25] op_sel_hi:[1,1,0]
    v_pk_add_f32 v[222:223], v[118:119], v[126:127]
    v_pk_fma_f32 v[230:231], v[118:119], v[118:119], s[24:25] op_sel_hi:[1,1,0]
    buffer_load_dwordx4 v17, s[12:15], s74 offen offset:1024 lds
    v_pk_add_f32 v[224:225], v[120:121], v[128:129]
    v_pk_fma_f32 v[232:233], v[120:121], v[120:121], s[24:25] op_sel_hi:[1,1,0]
    v_pk_add_f32 v[226:227], v[122:123], v[130:131]
    v_pk_fma_f32 v[234:235], v[122:123], v[122:123], s[24:25] op_sel_hi:[1,1,0]
    v_pk_fma_f32 v[228:229], v[124:125], v[124:125], v[228:229]
    v_pk_fma_f32 v[230:231], v[126:127], v[126:127], v[230:231]
    v_pk_fma_f32 v[232:233], v[128:129], v[128:129], v[232:233]
    v_pk_fma_f32 v[234:235], v[130:131], v[130:131], v[234:235]
    v_pk_add_f32 v[220:221], v[220:221], v[132:133]
    v_pk_fma_f32 v[228:229], v[132:133], v[132:133], v[228:229]
    v_pk_add_f32 v[222:223], v[222:223], v[134:135]
    v_pk_fma_f32 v[230:231], v[134:135], v[134:135], v[230:231]
    v_pk_add_f32 v[224:225], v[224:225], v[136:137]
    v_pk_fma_f32 v[232:233], v[136:137], v[136:137], v[232:233]
    v_pk_add_f32 v[226:227], v[226:227], v[138:139]
    v_pk_fma_f32 v[234:235], v[138:139], v[138:139], v[234:235]
    v_pk_add_f32 v[220:221], v[220:221], v[140:141]
    s_waitcnt vmcnt(10)
    s_nop 0
    ds_read_b128 a[32:35], v8 offset:0
    ds_read_b128 a[36:39], v9 offset:0
    ds_read_b128 a[40:43], v10 offset:0
    ds_read_b128 a[44:47], v11 offset:0
    buffer_load_dwordx4 v18, s[12:15], s74 offen offset:2048 lds
    v_pk_fma_f32 v[228:229], v[140:141], v[140:141], v[228:229]
    v_pk_add_f32 v[222:223], v[222:223], v[142:143]
    v_pk_fma_f32 v[230:231], v[142:143], v[142:143], v[230:231]
    v_pk_add_f32 v[224:225], v[224:225], v[144:145]
    v_pk_fma_f32 v[232:233], v[144:145], v[144:145], v[232:233]
    v_pk_add_f32 v[226:227], v[226:227], v[146:147]
    v_pk_fma_f32 v[234:235], v[146:147], v[146:147], v[234:235]
    v_add_f32_dpp v220, v220, v220 row_ror:8 row_mask:0xf bank_mask:0x3
    v_add_f32_dpp v221, v221, v221 row_ror:8 row_mask:0xf bank_mask:0x3
    v_add_f32_dpp v222, v222, v222 row_ror:8 row_mask:0xf bank_mask:0x3
    v_add_f32_dpp v223, v223, v223 row_ror:8 row_mask:0xf bank_mask:0x3
    v_add_f32_dpp v228, v228, v228 row_ror:8 row_mask:0xf bank_mask:0x3
    v_add_f32_dpp v229, v229, v229 row_ror:8 row_mask:0xf bank_mask:0x3
    v_add_f32_dpp v230, v230, v230 row_ror:8 row_mask:0xf bank_mask:0x3
    v_add_f32_dpp v231, v231, v231 row_ror:8 row_mask:0xf bank_mask:0x3
    v_add_f32_dpp v220, v224, v224 row_ror:8 row_mask:0xf bank_mask:0xc
    v_add_f32_dpp v221, v225, v225 row_ror:8 row_mask:0xf bank_mask:0xc
    v_add_f32_dpp v222, v226, v226 row_ror:8 row_mask:0xf bank_mask:0xc
    buffer_load_dwordx4 v19, s[12:15], s74 offen offset:3072 lds
    v_add_f32_dpp v223, v227, v227 row_ror:8 row_mask:0xf bank_mask:0xc
    v_add_f32_dpp v228, v232, v232 row_ror:8 row_mask:0xf bank_mask:0xc
    v_add_f32_dpp v229, v233, v233 row_ror:8 row_mask:0xf bank_mask:0xc
    v_add_f32_dpp v230, v234, v234 row_ror:8 row_mask:0xf bank_mask:0xc
    v_add_f32_dpp v231, v235, v235 row_ror:8 row_mask:0xf bank_mask:0xc
    v_add_f32_dpp v220, v220, v220 row_half_mirror row_mask:0xf bank_mask:0x5
    v_add_f32_dpp v221, v221, v221 row_half_mirror row_mask:0xf bank_mask:0x5
    v_add_f32_dpp v228, v228, v228 row_half_mirror row_mask:0xf bank_mask:0x5
    v_add_f32_dpp v229, v229, v229 row_half_mirror row_mask:0xf bank_mask:0x5
    v_add_f32_dpp v220, v222, v222 row_half_mirror row_mask:0xf bank_mask:0xa
    v_add_f32_dpp v221, v223, v223 row_half_mirror row_mask:0xf bank_mask:0xa
    v_add_f32_dpp v228, v230, v230 row_half_mirror row_mask:0xf bank_mask:0xa
    v_add_f32_dpp v229, v231, v231 row_half_mirror row_mask:0xf bank_mask:0xa
    v_add_f32_dpp v220, v220, v220 quad_perm:[1,0,3,2] row_mask:0xf bank_mask:0xf
    v_add_f32_dpp v221, v221, v221 quad_perm:[1,0,3,2] row_mask:0xf bank_mask:0xf
    v_add_f32_dpp v228, v228, v228 quad_perm:[1,0,3,2] row_mask:0xf bank_mask:0xf
    v_add_f32_dpp v229, v229, v229 quad_perm:[1,0,3,2] row_mask:0xf bank_mask:0xf
    v_add_f32_dpp v220, v220, v220 quad_perm:[2,3,0,1] row_mask:0xf bank_mask:0xf
    v_add_f32_dpp v221, v221, v221 quad_perm:[2,3,0,1] row_mask:0xf bank_mask:0xf
    v_add_f32_dpp v228, v228, v228 quad_perm:[2,3,0,1] row_mask:0xf bank_mask:0xf
    v_add_f32_dpp v229, v229, v229 quad_perm:[2,3,0,1] row_mask:0xf bank_mask:0xf
    v_mul_f32 v220, 0x3e000000, v220
    v_mul_f32 v221, 0x3e000000, v221
    v_pk_fma_f32 v[228:229], v[220:221], v[220:221], v[228:229] neg_lo:[1,0,0] neg_hi:[1,0,0]
    v_cndmask_b32 v220, v220, v221, s[28:29]
    v_cndmask_b32 v228, v228, v229, s[28:29]
    v_cndmask_b32 v220, v220, v228, s[30:31]
    v_perm_b32 v32, v220, v43, v33
    buffer_store_dword v32, v42, s[16:19], s75 offen sc1
    s_barrier
    ds_read_b64_tr_b16 v[148:149], v24 offset:16384
    ds_read_b64_tr_b16 v[150:151], v24 offset:16896
    s_nop 0
    ds_read_b64_tr_b16 v[152:153], v25 offset:16384
    ds_read_b64_tr_b16 v[154:155], v25 offset:16896
    ds_read_b64_tr_b16 v[156:157], v26 offset:16384
    ds_read_b64_tr_b16 v[158:159], v26 offset:16896
    ds_read_b64_tr_b16 v[160:161], v27 offset:16384
    ds_read_b64_tr_b16 v[162:163], v27 offset:16896
    s_add_u32 m0, s73, 0
    s_nop 0
    buffer_load_dwordx4 v20, s[8:11], s66 offen offset:0 lds
    s_waitcnt lgkmcnt(4)
    v_mfma_f32_16x16x32_bf16 v[180:183], v[148:151], a[160:163], 0
    ds_read_b64_tr_b16 v[164:165], v24 offset:17408
    v_mfma_f32_16x16x32_bf16 v[196:199], v[148:151], a[164:167], 0
    s_nop 0
    ds_read_b64_tr_b16 v[166:167], v24 offset:17920
    v_mfma_f32_16x16x32_bf16 v[184:187], v[152:155], a[160:163], 0
    ds_read_b64_tr_b16 v[168:169], v25 offset:17408
    buffer_load_dwordx4 v21, s[8:11], s66 offen offset:1024 lds
    v_mfma_f32_16x16x32_bf16 v[200:203], v[152:155], a[164:167], 0
    ds_read_b64_tr_b16 v[170:171], v25 offset:17920
    s_waitcnt lgkmcnt(4)
    v_mfma_f32_16x16x32_bf16 v[188:191], v[156:159], a[160:163], 0
    s_nop 0
    ds_read_b64_tr_b16 v[172:173], v26 offset:17408
    v_mfma_f32_16x16x32_bf16 v[204:207], v[156:159], a[164:167], 0
    ds_read_b64_tr_b16 v[174:175], v26 offset:17920
    v_mfma_f32_16x16x32_bf16 v[192:195], v[160:163], a[160:163], 0
    ds_read_b64_tr_b16 v[176:177], v27 offset:17408
    v_mfma_f32_16x16x32_bf16 v[208:211], v[160:163], a[164:167], 0
    buffer_load_dwordx4 v22, s[8:11], s66 offen offset:2048 lds
    ds_read_b64_tr_b16 v[178:179], v27 offset:17920
    s_waitcnt lgkmcnt(4)
    v_mfma_f32_16x16x32_bf16 v[180:183], v[164:167], a[168:171], v[180:183]
    ds_read_b64_tr_b16 v[148:149], v24 offset:18432
    v_mfma_f32_16x16x32_bf16 v[196:199], v[164:167], a[172:175], v[196:199]
    s_nop 0
    ds_read_b64_tr_b16 v[150:151], v24 offset:18944
    v_mfma_f32_16x16x32_bf16 v[184:187], v[168:171], a[168:171], v[184:187]
    ds_read_b64_tr_b16 v[152:153], v25 offset:18432
    v_mfma_f32_16x16x32_bf16 v[200:203], v[168:171], a[172:175], v[200:203]
    ds_read_b64_tr_b16 v[154:155], v25 offset:18944
    buffer_load_dwordx4 v23, s[8:11], s66 offen offset:3072 lds
    s_waitcnt lgkmcnt(4)
    v_mfma_f32_16x16x32_bf16 v[188:191], v[172:175], a[168:171], v[188:191]
    s_nop 0
    ds_read_b64_tr_b16 v[156:157], v26 offset:18432
    v_mfma_f32_16x16x32_bf16 v[204:207], v[172:175], a[172:175], v[204:207]
    ds_read_b64_tr_b16 v[158:159], v26 offset:18944
    v_mfma_f32_16x16x32_bf16 v[192:195], v[176:179], a[168:171], v[192:195]
    ds_read_b64_tr_b16 v[160:161], v27 offset:18432
    v_mfma_f32_16x16x32_bf16 v[208:211], v[176:179], a[172:175], v[208:211]
    ds_read_b64_tr_b16 v[162:163], v27 offset:18944
    s_waitcnt lgkmcnt(4)
    s_nop 0
    v_mfma_f32_16x16x32_bf16 v[180:183], v[148:151], a[176:179], v[180:183]
    s_waitcnt vmcnt(9)
    ds_read_b128 a[48:51], v8 offset:4096
    ds_read_b128 a[52:55], v9 offset:4096
    s_nop 0
    ds_read_b128 a[56:59], v10 offset:4096
    ds_read_b128 a[60:63], v11 offset:4096
    s_add_u32 m0, s72, 12288
    s_add_u32 s74, s33, s37
    s_nop 0
    buffer_load_dwordx4 v16, s[12:15], s74 offen offset:0 lds
    ds_read_b64_tr_b16 v[164:165], v24 offset:19456
    v_mfma_f32_16x16x32_bf16 v[196:199], v[148:151], a[180:183], v[196:199]
    ds_read_b64_tr_b16 v[166:167], v24 offset:19968
    v_mfma_f32_16x16x32_bf16 v[184:187], v[152:155], a[176:179], v[184:187]
    ds_read_b64_tr_b16 v[168:169], v25 offset:19456
    v_mfma_f32_16x16x32_bf16 v[200:203], v[152:155], a[180:183], v[200:203]
    ds_read_b64_tr_b16 v[170:171], v25 offset:19968
    s_waitcnt lgkmcnt(8)
    v_mfma_f32_16x16x32_bf16 v[188:191], v[156:159], a[176:179], v[188:191]
    ds_read_b64_tr_b16 v[172:173], v26 offset:19456
    v_mfma_f32_16x16x32_bf16 v[204:207], v[156:159], a[180:183], v[204:207]
    s_nop 0
    buffer_load_dwordx4 v17, s[12:15], s74 offen offset:1024 lds
    ds_read_b64_tr_b16 v[174:175], v26 offset:19968
    v_mfma_f32_16x16x32_bf16 v[192:195], v[160:163], a[176:179], v[192:195]
    ds_read_b64_tr_b16 v[176:177], v27 offset:19456
    v_mfma_f32_16x16x32_bf16 v[208:211], v[160:163], a[180:183], v[208:211]
    ds_read_b64_tr_b16 v[178:179], v27 offset:19968
    buffer_load_dwordx4 v18, s[12:15], s74 offen offset:2048 lds
    s_waitcnt lgkmcnt(0)
    s_barrier
    buffer_load_dwordx4 v19, s[12:15], s74 offen offset:3072 lds
    v_mfma_f32_16x16x32_bf16 v[180:183], v[164:167], a[184:187], v[180:183]
    ds_read_b64_tr_b16 v[148:149], v24 offset:32768
    v_mfma_f32_16x16x32_bf16 v[196:199], v[164:167], a[188:191], v[196:199]
    ds_read_b64_tr_b16 v[150:151], v24 offset:33280
    v_mfma_f32_16x16x32_bf16 v[184:187], v[168:171], a[184:187], v[184:187]
    ds_read_b64_tr_b16 v[152:153], v25 offset:32768
    v_mfma_f32_16x16x32_bf16 v[200:203], v[168:171], a[188:191], v[200:203]
    ds_read_b64_tr_b16 v[154:155], v25 offset:33280
    v_mfma_f32_16x16x32_bf16 v[188:191], v[172:175], a[184:187], v[188:191]
    s_add_u32 m0, s72, 16384
    s_add_u32 s74, s33, s38
    s_nop 0
    buffer_load_dwordx4 v16, s[12:15], s74 offen offset:0 lds
    s_waitcnt vmcnt(10)
    ds_read_b128 a[64:67], v8 offset:8192
    ds_read_b128 a[68:71], v9 offset:8192
    s_nop 0
    ds_read_b128 a[72:75], v10 offset:8192
    ds_read_b128 a[76:79], v11 offset:8192
    ds_read_b64_tr_b16 v[156:157], v26 offset:32768
    v_mfma_f32_16x16x32_bf16 v[204:207], v[172:175], a[188:191], v[204:207]
    ds_read_b64_tr_b16 v[158:159], v26 offset:33280
    v_mfma_f32_16x16x32_bf16 v[192:195], v[176:179], a[184:187], v[192:195]
    ds_read_b64_tr_b16 v[160:161], v27 offset:32768
    v_mfma_f32_16x16x32_bf16 v[208:211], v[176:179], a[188:191], v[208:211]
    ds_read_b64_tr_b16 v[162:163], v27 offset:33280
    buffer_load_dwordx4 v17, s[12:15], s74 offen offset:1024 lds
    s_waitcnt lgkmcnt(8)
    v_mfma_f32_16x16x32_bf16 v[180:183], v[148:151], a[192:195], v[180:183]
    s_nop 0
    buffer_load_dwordx4 v[236:239], v41, s[16:19], s75 offen offset:0 sc1
    buffer_load_dwordx4 v[240:243], v41, s[16:19], s75 offen offset:1024 sc1
    buffer_load_dwordx4 v[244:247], v41, s[16:19], s75 offen offset:2048 sc1
    ds_read_b64_tr_b16 v[164:165], v24 offset:33792
    v_mfma_f32_16x16x32_bf16 v[196:199], v[148:151], a[196:199], v[196:199]
    ds_read_b64_tr_b16 v[166:167], v24 offset:34304
    v_mfma_f32_16x16x32_bf16 v[184:187], v[152:155], a[192:195], v[184:187]
    ds_read_b64_tr_b16 v[168:169], v25 offset:33792
    v_mfma_f32_16x16x32_bf16 v[200:203], v[152:155], a[196:199], v[200:203]
    ds_read_b64_tr_b16 v[170:171], v25 offset:34304
    s_waitcnt lgkmcnt(4)
    v_mfma_f32_16x16x32_bf16 v[188:191], v[156:159], a[192:195], v[188:191]
    s_nop 0
    ds_read_b64_tr_b16 v[172:173], v26 offset:33792
    v_mfma_f32_16x16x32_bf16 v[204:207], v[156:159], a[196:199], v[204:207]
    buffer_load_dwordx4 v18, s[12:15], s74 offen offset:2048 lds
    ds_read_b64_tr_b16 v[174:175], v26 offset:34304
    v_mfma_f32_16x16x32_bf16 v[192:195], v[160:163], a[192:195], v[192:195]
    ds_read_b64_tr_b16 v[176:177], v27 offset:33792
    v_mfma_f32_16x16x32_bf16 v[208:211], v[160:163], a[196:199], v[208:211]
    ds_read_b64_tr_b16 v[178:179], v27 offset:34304
    s_waitcnt lgkmcnt(4)
    v_mfma_f32_16x16x32_bf16 v[180:183], v[164:167], a[200:203], v[180:183]
    ds_read_b64_tr_b16 v[148:149], v24 offset:34816
    v_mfma_f32_16x16x32_bf16 v[196:199], v[164:167], a[204:207], v[196:199]
    s_nop 0
    ds_read_b64_tr_b16 v[150:151], v24 offset:35328
    buffer_load_dwordx4 v19, s[12:15], s74 offen offset:3072 lds
    v_mfma_f32_16x16x32_bf16 v[184:187], v[168:171], a[200:203], v[184:187]
    ds_read_b64_tr_b16 v[152:153], v25 offset:34816
    v_mfma_f32_16x16x32_bf16 v[200:203], v[168:171], a[204:207], v[200:203]
    ds_read_b64_tr_b16 v[154:155], v25 offset:35328
    s_waitcnt lgkmcnt(4)
    v_mfma_f32_16x16x32_bf16 v[188:191], v[172:175], a[200:203], v[188:191]
    s_nop 0
    ds_read_b64_tr_b16 v[156:157], v26 offset:34816
    v_mfma_f32_16x16x32_bf16 v[204:207], v[172:175], a[204:207], v[204:207]
    ds_read_b64_tr_b16 v[158:159], v26 offset:35328
    v_mfma_f32_16x16x32_bf16 v[192:195], v[176:179], a[200:203], v[192:195]
    s_add_u32 m0, s72, 20480
    s_add_u32 s74, s33, s39
    buffer_load_dwordx4 v16, s[12:15], s74 offen offset:0 lds
    ds_read_b64_tr_b16 v[160:161], v27 offset:34816
    s_nop 0
    v_mfma_f32_16x16x32_bf16 v[208:211], v[176:179], a[204:207], v[208:211]
    ds_read_b64_tr_b16 v[162:163], v27 offset:35328
    s_waitcnt lgkmcnt(4)
    v_mfma_f32_16x16x32_bf16 v[180:183], v[148:151], a[208:211], v[180:183]
    s_nop 0
    ds_read_b64_tr_b16 v[164:165], v24 offset:35840
    v_mfma_f32_16x16x32_bf16 v[196:199], v[148:151], a[212:215], v[196:199]
    ds_read_b64_tr_b16 v[166:167], v24 offset:36352
    v_mfma_f32_16x16x32_bf16 v[184:187], v[152:155], a[208:211], v[184:187]
    ds_read_b64_tr_b16 v[168:169], v25 offset:35840
    v_mfma_f32_16x16x32_bf16 v[200:203], v[152:155], a[212:215], v[200:203]
    buffer_load_dwordx4 v17, s[12:15], s74 offen offset:1024 lds
    ds_read_b64_tr_b16 v[170:171], v25 offset:36352
    s_waitcnt lgkmcnt(4)
    v_mfma_f32_16x16x32_bf16 v[188:191], v[156:159], a[208:211], v[188:191]
    ds_read_b64_tr_b16 v[172:173], v26 offset:35840
    v_mfma_f32_16x16x32_bf16 v[204:207], v[156:159], a[212:215], v[204:207]
    s_nop 0
    ds_read_b64_tr_b16 v[174:175], v26 offset:36352
    v_mfma_f32_16x16x32_bf16 v[192:195], v[160:163], a[208:211], v[192:195]
    ds_read_b64_tr_b16 v[176:177], v27 offset:35840
    v_mfma_f32_16x16x32_bf16 v[208:211], v[160:163], a[212:215], v[208:211]
    ds_read_b64_tr_b16 v[178:179], v27 offset:36352
    buffer_load_dwordx4 v18, s[12:15], s74 offen offset:2048 lds
    s_waitcnt lgkmcnt(0)
    s_barrier
    buffer_load_dwordx4 v19, s[12:15], s74 offen offset:3072 lds
    v_mfma_f32_16x16x32_bf16 v[180:183], v[164:167], a[216:219], v[180:183]
    ds_read_b64_tr_b16 v[148:149], v24 offset:49152
    v_mfma_f32_16x16x32_bf16 v[196:199], v[164:167], a[220:223], v[196:199]
    ds_read_b64_tr_b16 v[150:151], v24 offset:49664
    v_mfma_f32_16x16x32_bf16 v[184:187], v[168:171], a[216:219], v[184:187]
    ds_read_b64_tr_b16 v[152:153], v25 offset:49152
    v_mfma_f32_16x16x32_bf16 v[200:203], v[168:171], a[220:223], v[200:203]
    ds_read_b64_tr_b16 v[154:155], v25 offset:49664
    v_mfma_f32_16x16x32_bf16 v[188:191], v[172:175], a[216:219], v[188:191]
    s_add_u32 m0, s73, 16384
    s_nop 0
    buffer_load_dwordx4 v20, s[8:11], s67 offen offset:0 lds
    s_nop 0
    ds_read_b64_tr_b16 v[156:157], v26 offset:49152
    v_mfma_f32_16x16x32_bf16 v[204:207], v[172:175], a[220:223], v[204:207]
    s_waitcnt vmcnt(12)
    ds_read_b128 a[80:83], v8 offset:12288
    s_nop 0
    ds_read_b128 a[84:87], v9 offset:12288
    ds_read_b128 a[88:91], v10 offset:12288
    ds_read_b128 a[92:95], v11 offset:12288
    ds_read_b64_tr_b16 v[158:159], v26 offset:49664
    v_mfma_f32_16x16x32_bf16 v[192:195], v[176:179], a[216:219], v[192:195]
    ds_read_b64_tr_b16 v[160:161], v27 offset:49152
    v_mfma_f32_16x16x32_bf16 v[208:211], v[176:179], a[220:223], v[208:211]
    ds_read_b64_tr_b16 v[162:163], v27 offset:49664
    buffer_load_dwordx4 v21, s[8:11], s67 offen offset:1024 lds
    s_waitcnt lgkmcnt(8)
    v_mfma_f32_16x16x32_bf16 v[180:183], v[148:151], a[224:227], v[180:183]
    ds_read_b64_tr_b16 v[164:165], v24 offset:50176
    s_nop 0
    v_mfma_f32_16x16x32_bf16 v[196:199], v[148:151], a[228:231], v[196:199]
    ds_read_b64_tr_b16 v[166:167], v24 offset:50688
    v_mfma_f32_16x16x32_bf16 v[184:187], v[152:155], a[224:227], v[184:187]
    ds_read_b64_tr_b16 v[168:169], v25 offset:50176
    v_mfma_f32_16x16x32_bf16 v[200:203], v[152:155], a[228:231], v[200:203]
    ds_read_b64_tr_b16 v[170:171], v25 offset:50688
    s_waitcnt lgkmcnt(4)
    v_mfma_f32_16x16x32_bf16 v[188:191], v[156:159], a[224:227], v[188:191]
    s_nop 0
    buffer_load_dwordx4 v22, s[8:11], s67 offen offset:2048 lds
    ds_read_b64_tr_b16 v[172:173], v26 offset:50176
    v_mfma_f32_16x16x32_bf16 v[204:207], v[156:159], a[228:231], v[204:207]
    ds_read_b64_tr_b16 v[174:175], v26 offset:50688
    v_mfma_f32_16x16x32_bf16 v[192:195], v[160:163], a[224:227], v[192:195]
    ds_read_b64_tr_b16 v[176:177], v27 offset:50176
    v_mfma_f32_16x16x32_bf16 v[208:211], v[160:163], a[228:231], v[208:211]
    ds_read_b64_tr_b16 v[178:179], v27 offset:50688
    s_waitcnt vmcnt(9)
    v_xor_b32 v247, v255, v247
    v_xor_b32 v246, v254, v246
    v_xor_b32 v245, v253, v245
    v_xor_b32 v244, v252, v244
    v_xor_b32 v243, v255, v243
    v_xor_b32 v242, v254, v242
    v_xor_b32 v241, v253, v241
    v_xor_b32 v240, v252, v240
    v_xor_b32 v239, v255, v239
    v_xor_b32 v238, v254, v238
    v_xor_b32 v237, v253, v237
    v_xor_b32_e64 v236, v252, v236
    v_or3_b32 v32, v247, v246, v245
    v_or3_b32 v33, v244, v243, v242
    v_or3_b32 v32, v32, v241, v240
    v_or3_b32 v33, v33, v239, v238
    v_or3_b32 v32, v32, v237, v236
    v_or_b32_e64 v32, v32, v33
    v_and_b32 v32, 0xff, v32
    v_cmp_ne_u32 vcc, 0, v32
    s_cbranch_vccnz L_slow1
L_ok1:
    buffer_load_dwordx4 v23, s[8:11], s67 offen offset:3072 lds
    v_pk_fma_f32 v[238:239], v[236:237], v[236:237], v[238:239]
    v_pk_fma_f32 v[242:243], v[240:241], v[240:241], v[242:243]
    v_pk_fma_f32 v[246:247], v[244:245], v[244:245], v[246:247]
    v_pk_add_f32 v[236:237], v[236:237], v[240:241]
    v_pk_add_f32 v[236:237], v[236:237], v[244:245]
    v_pk_add_f32 v[238:239], v[238:239], v[242:243]
    v_pk_add_f32 v[238:239], v[238:239], v[246:247]
    v_add_f32_dpp v236, v236, v236 row_ror:4 row_mask:0xf bank_mask:0xf
    v_add_f32_dpp v237, v237, v237 row_ror:4 row_mask:0xf bank_mask:0xf
    v_add_f32_dpp v238, v238, v238 row_ror:4 row_mask:0xf bank_mask:0xf
    v_add_f32_dpp v239, v239, v239 row_ror:4 row_mask:0xf bank_mask:0xf
    v_add_f32_dpp v236, v236, v236 row_ror:8 row_mask:0xf bank_mask:0xf
    v_add_f32_dpp v237, v237, v237 row_ror:8 row_mask:0xf bank_mask:0xf
    v_add_f32_dpp v238, v238, v238 row_ror:8 row_mask:0xf bank_mask:0xf
    v_add_f32_dpp v239, v239, v239 row_ror:8 row_mask:0xf bank_mask:0xf
    v_pk_mul_f32 v[240:241], v[236:237], s[24:25] op_sel:[0,1]
    v_pk_fma_f32 v[238:239], v[240:241], v[236:237], v[238:239] neg_lo:[1,0,0] neg_hi:[1,0,0]
    v_max_f32 v238, 0x3bfba882, v238
    v_max_f32 v239, 0x3bfba882, v239
    v_rsq_f32 v238, v238
    v_rsq_f32 v239, v239
    v_pk_mul_f32 v[236:237], v[236:237], s[26:27] op_sel:[0,1]
    v_pk_mul_f32 v[240:241], v[238:239], s[26:27] op_sel_hi:[1,0]
    v_pk_mul_f32 v[236:237], v[236:237], v[238:239]
    s_nop 0
    s_nop 0
    v_mov_b64_dpp v[220:221], v[240:241] row_newbcast:0 row_mask:0xf bank_mask:0xf
    v_mov_b64_dpp v[222:223], v[240:241] row_newbcast:1 row_mask:0xf bank_mask:0xf
    v_mov_b64_dpp v[224:225], v[240:241] row_newbcast:2 row_mask:0xf bank_mask:0xf
    v_mov_b64_dpp v[226:227], v[240:241] row_newbcast:3 row_mask:0xf bank_mask:0xf
    v_mov_b64_dpp v[228:229], v[236:237] row_newbcast:0 row_mask:0xf bank_mask:0xf
    v_mov_b64_dpp v[230:231], v[236:237] row_newbcast:1 row_mask:0xf bank_mask:0xf
    v_mov_b64_dpp v[232:233], v[236:237] row_newbcast:2 row_mask:0xf bank_mask:0xf
    v_mov_b64_dpp v[234:235], v[236:237] row_newbcast:3 row_mask:0xf bank_mask:0xf
    v_pk_fma_f32 v[116:117], v[116:117], v[220:221], v[228:229] neg_lo:[0,0,1] neg_hi:[0,0,1]
    v_pk_fma_f32 v[118:119], v[118:119], v[222:223], v[230:231] neg_lo:[0,0,1] neg_hi:[0,0,1]
    v_pk_fma_f32 v[120:121], v[120:121], v[224:225], v[232:233] neg_lo:[0,0,1] neg_hi:[0,0,1]
    v_pk_fma_f32 v[122:123], v[122:123], v[226:227], v[234:235] neg_lo:[0,0,1] neg_hi:[0,0,1]
    s_add_u32 m0, s72, 0
    s_add_u32 s74, s34, s36
    buffer_load_dwordx4 v16, s[12:15], s74 offen offset:0 lds
    s_waitcnt vmcnt(9)
    ds_read_b128 a[96:99], v8 offset:16384
    s_nop 0
    ds_read_b128 a[100:103], v9 offset:16384
    ds_read_b128 a[104:107], v10 offset:16384
    ds_read_b128 a[108:111], v11 offset:16384
    v_pk_fma_f32 v[124:125], v[124:125], v[220:221], v[228:229] neg_lo:[0,0,1] neg_hi:[0,0,1]
    v_pk_fma_f32 v[126:127], v[126:127], v[222:223], v[230:231] neg_lo:[0,0,1] neg_hi:[0,0,1]
    v_pk_fma_f32 v[128:129], v[128:129], v[224:225], v[232:233] neg_lo:[0,0,1] neg_hi:[0,0,1]
    v_pk_fma_f32 v[130:131], v[130:131], v[226:227], v[234:235] neg_lo:[0,0,1] neg_hi:[0,0,1]
    v_cvt_pk_bf16_f32 v116, v116, v117
    v_cvt_pk_bf16_f32 v117, v118, v119
    v_cvt_pk_bf16_f32 v118, v124, v125
    v_cvt_pk_bf16_f32 v119, v126, v127
    v_cvt_pk_bf16_f32 v120, v120, v121
    v_cvt_pk_bf16_f32 v121, v122, v123
    v_cvt_pk_bf16_f32 v122, v128, v129
    v_cvt_pk_bf16_f32 v123, v130, v131
    v_permlane16_swap_b32 v116, v118
    v_permlane16_swap_b32 v117, v119
    buffer_store_dwordx4 v[116:119], v38, s[16:19], s76 offen sc1
    s_xor_b32 s76, s76, 4096
    v_permlane16_swap_b32 v120, v122
    v_permlane16_swap_b32 v121, v123
    buffer_store_dwordx4 v[120:123], v38, s[16:19], s76 offen sc1
    v_pk_fma_f32 v[132:133], v[132:133], v[220:221], v[228:229] neg_lo:[0,0,1] neg_hi:[0,0,1]
    v_pk_fma_f32 v[134:135], v[134:135], v[222:223], v[230:231] neg_lo:[0,0,1] neg_hi:[0,0,1]
    v_pk_fma_f32 v[136:137], v[136:137], v[224:225], v[232:233] neg_lo:[0,0,1] neg_hi:[0,0,1]
    v_pk_fma_f32 v[138:139], v[138:139], v[226:227], v[234:235] neg_lo:[0,0,1] neg_hi:[0,0,1]
    v_pk_fma_f32 v[140:141], v[140:141], v[220:221], v[228:229] neg_lo:[0,0,1] neg_hi:[0,0,1]
    v_pk_fma_f32 v[142:143], v[142:143], v[222:223], v[230:231] neg_lo:[0,0,1] neg_hi:[0,0,1]
    v_pk_fma_f32 v[144:145], v[144:145], v[224:225], v[232:233] neg_lo:[0,0,1] neg_hi:[0,0,1]
    v_pk_fma_f32 v[146:147], v[146:147], v[226:227], v[234:235] neg_lo:[0,0,1] neg_hi:[0,0,1]
    v_cvt_pk_bf16_f32 v132, v132, v133
    v_cvt_pk_bf16_f32 v133, v134, v135
    v_cvt_pk_bf16_f32 v134, v140, v141
    v_cvt_pk_bf16_f32 v135, v142, v143
    v_cvt_pk_bf16_f32 v136, v136, v137
    v_cvt_pk_bf16_f32 v137, v138, v139
    v_cvt_pk_bf16_f32 v138, v144, v145
    v_cvt_pk_bf16_f32 v139, v146, v147
    s_add_u32 s76, s76, 131072
    v_permlane16_swap_b32 v136, v138
    v_permlane16_swap_b32 v137, v139
    buffer_store_dwordx4 v[136:139], v38, s[16:19], s76 offen sc1
    s_xor_b32 s76, s76, 4096
    v_permlane16_swap_b32 v132, v134
    v_permlane16_swap_b32 v133, v135
    buffer_store_dwordx4 v[132:135], v38, s[16:19], s76 offen sc1
    s_waitcnt lgkmcnt(8)
    v_mfma_f32_16x16x32_bf16 v[180:183], v[164:167], a[232:235], v[180:183]
    s_nop 0
    ds_read_b64_tr_b16 v[148:149], v24 offset:51200
    v_mfma_f32_16x16x32_bf16 v[196:199], v[164:167], a[236:239], v[196:199]
    ds_read_b64_tr_b16 v[150:151], v24 offset:51712
    v_mfma_f32_16x16x32_bf16 v[184:187], v[168:171], a[232:235], v[184:187]
    ds_read_b64_tr_b16 v[152:153], v25 offset:51200
    v_mfma_f32_16x16x32_bf16 v[200:203], v[168:171], a[236:239], v[200:203]
    s_waitcnt vmcnt(9)
    ds_read_b128 a[112:115], v8 offset:20480
    s_nop 0
    ds_read_b128 a[116:119], v9 offset:20480
    ds_read_b128 a[120:123], v10 offset:20480
    ds_read_b128 a[124:127], v11 offset:20480
    buffer_load_dwordx4 v17, s[12:15], s74 offen offset:1024 lds
    ds_read_b64_tr_b16 v[154:155], v25 offset:51712
    s_waitcnt lgkmcnt(12)
    v_mfma_f32_16x16x32_bf16 v[188:191], v[172:175], a[232:235], v[188:191]
    ds_read_b64_tr_b16 v[156:157], v26 offset:51200
    s_nop 0
    v_mfma_f32_16x16x32_bf16 v[204:207], v[172:175], a[236:239], v[204:207]
    ds_read_b64_tr_b16 v[158:159], v26 offset:51712
    v_mfma_f32_16x16x32_bf16 v[192:195], v[176:179], a[232:235], v[192:195]
    ds_read_b64_tr_b16 v[160:161], v27 offset:51200
    v_mfma_f32_16x16x32_bf16 v[208:211], v[176:179], a[236:239], v[208:211]
    ds_read_b64_tr_b16 v[162:163], v27 offset:51712
    buffer_load_dwordx4 v18, s[12:15], s74 offen offset:2048 lds
    s_waitcnt lgkmcnt(4)
    s_nop 0
    v_mfma_f32_16x16x32_bf16 v[180:183], v[148:151], a[240:243], v[180:183]
    ds_read_b64_tr_b16 v[164:165], v24 offset:52224
    v_mfma_f32_16x16x32_bf16 v[196:199], v[148:151], a[244:247], v[196:199]
    ds_read_b64_tr_b16 v[166:167], v24 offset:52736
    v_mfma_f32_16x16x32_bf16 v[184:187], v[152:155], a[240:243], v[184:187]
    ds_read_b64_tr_b16 v[168:169], v25 offset:52224
    v_mfma_f32_16x16x32_bf16 v[200:203], v[152:155], a[244:247], v[200:203]
    ds_read_b64_tr_b16 v[170:171], v25 offset:52736
    s_waitcnt lgkmcnt(4)
    v_mfma_f32_16x16x32_bf16 v[188:191], v[156:159], a[240:243], v[188:191]
    buffer_load_dwordx4 v19, s[12:15], s74 offen offset:3072 lds
    ds_read_b64_tr_b16 v[172:173], v26 offset:52224
    s_nop 0
    v_mfma_f32_16x16x32_bf16 v[204:207], v[156:159], a[244:247], v[204:207]
    ds_read_b64_tr_b16 v[174:175], v26 offset:52736
    v_mfma_f32_16x16x32_bf16 v[192:195], v[160:163], a[240:243], v[192:195]
    ds_read_b64_tr_b16 v[176:177], v27 offset:52224
    v_mfma_f32_16x16x32_bf16 v[208:211], v[160:163], a[244:247], v[208:211]
    ds_read_b64_tr_b16 v[178:179], v27 offset:52736
    s_add_u32 m0, s72, 4096
    s_add_u32 s74, s34, s37
    s_nop 0
    buffer_load_dwordx4 v16, s[12:15], s74 offen offset:0 lds
    s_waitcnt lgkmcnt(0)
    s_barrier
    v_mfma_f32_16x16x32_bf16 v[180:183], v[164:167], a[248:251], v[180:183]
    buffer_load_dwordx4 v17, s[12:15], s74 offen offset:1024 lds
    ds_read_b64_tr_b16 v[148:149], v24 offset:0
    v_mfma_f32_16x16x32_bf16 v[196:199], v[164:167], a[252:255], v[196:199]
    ds_read_b64_tr_b16 v[150:151], v24 offset:512
    v_mfma_f32_16x16x32_bf16 v[184:187], v[168:171], a[248:251], v[184:187]
    ds_read_b64_tr_b16 v[152:153], v25 offset:0
    v_mfma_f32_16x16x32_bf16 v[200:203], v[168:171], a[252:255], v[200:203]
    ds_read_b64_tr_b16 v[154:155], v25 offset:512
    v_mfma_f32_16x16x32_bf16 v[188:191], v[172:175], a[248:251], v[188:191]
    ds_read_b64_tr_b16 v[156:157], v26 offset:0
    v_mfma_f32_16x16x32_bf16 v[204:207], v[172:175], a[252:255], v[204:207]
    buffer_load_dwordx4 v18, s[12:15], s74 offen offset:2048 lds
    ds_read_b64_tr_b16 v[158:159], v26 offset:512
    v_mfma_f32_16x16x32_bf16 v[192:195], v[176:179], a[248:251], v[192:195]
    ds_read_b64_tr_b16 v[160:161], v27 offset:0
    v_mfma_f32_16x16x32_bf16 v[208:211], v[176:179], a[252:255], v[208:211]
    ds_read_b64_tr_b16 v[162:163], v27 offset:512
    s_waitcnt lgkmcnt(4)
    v_mfma_f32_16x16x32_bf16 v[180:183], v[148:151], v[52:55], v[180:183]
    ds_read_b64_tr_b16 v[164:165], v24 offset:1024
    v_mfma_f32_16x16x32_bf16 v[196:199], v[148:151], v[56:59], v[196:199]
    s_nop 0
    ds_read_b64_tr_b16 v[166:167], v24 offset:1536
    buffer_load_dwordx4 v19, s[12:15], s74 offen offset:3072 lds
    v_mfma_f32_16x16x32_bf16 v[184:187], v[152:155], v[52:55], v[184:187]
    ds_read_b64_tr_b16 v[168:169], v25 offset:1024
    v_mfma_f32_16x16x32_bf16 v[200:203], v[152:155], v[56:59], v[200:203]
    ds_read_b64_tr_b16 v[170:171], v25 offset:1536
    s_waitcnt lgkmcnt(4)
    v_mfma_f32_16x16x32_bf16 v[188:191], v[156:159], v[52:55], v[188:191]
    s_nop 0
    ds_read_b64_tr_b16 v[172:173], v26 offset:1024
    v_mfma_f32_16x16x32_bf16 v[204:207], v[156:159], v[56:59], v[204:207]
    ds_read_b64_tr_b16 v[174:175], v26 offset:1536
    v_mfma_f32_16x16x32_bf16 v[192:195], v[160:163], v[52:55], v[192:195]
    s_add_u32 m0, s72, 8192
    s_add_u32 s74, s34, s38
    buffer_load_dwordx4 v16, s[12:15], s74 offen offset:0 lds
    ds_read_b64_tr_b16 v[176:177], v27 offset:1024
    s_nop 0
    v_mfma_f32_16x16x32_bf16 v[208:211], v[160:163], v[56:59], v[208:211]
    ds_read_b64_tr_b16 v[178:179], v27 offset:1536
    s_waitcnt lgkmcnt(4)
    v_mfma_f32_16x16x32_bf16 v[180:183], v[164:167], v[60:63], v[180:183]
    s_nop 0
    ds_read_b64_tr_b16 v[148:149], v24 offset:2048
    v_mfma_f32_16x16x32_bf16 v[196:199], v[164:167], v[64:67], v[196:199]
    ds_read_b64_tr_b16 v[150:151], v24 offset:2560
    v_mfma_f32_16x16x32_bf16 v[184:187], v[168:171], v[60:63], v[184:187]
    ds_read_b64_tr_b16 v[152:153], v25 offset:2048
    v_mfma_f32_16x16x32_bf16 v[200:203], v[168:171], v[64:67], v[200:203]
    buffer_load_dwordx4 v17, s[12:15], s74 offen offset:1024 lds
    ds_read_b64_tr_b16 v[154:155], v25 offset:2560
    s_waitcnt lgkmcnt(4)
    v_mfma_f32_16x16x32_bf16 v[188:191], v[172:175], v[60:63], v[188:191]
    ds_read_b64_tr_b16 v[156:157], v26 offset:2048
    v_mfma_f32_16x16x32_bf16 v[204:207], v[172:175], v[64:67], v[204:207]
    s_nop 0
    ds_read_b64_tr_b16 v[158:159], v26 offset:2560
    v_mfma_f32_16x16x32_bf16 v[192:195], v[176:179], v[60:63], v[192:195]
    ds_read_b64_tr_b16 v[160:161], v27 offset:2048
    v_mfma_f32_16x16x32_bf16 v[208:211], v[176:179], v[64:67], v[208:211]
    ds_read_b64_tr_b16 v[162:163], v27 offset:2560
    buffer_load_dwordx4 v18, s[12:15], s74 offen offset:2048 lds
    s_waitcnt lgkmcnt(4)
    v_mfma_f32_16x16x32_bf16 v[180:183], v[148:151], v[68:71], v[180:183]
    s_nop 0
    ds_read_b64_tr_b16 v[164:165], v24 offset:3072
    v_mfma_f32_16x16x32_bf16 v[196:199], v[148:151], v[72:75], v[196:199]
    ds_read_b64_tr_b16 v[166:167], v24 offset:3584
    s_waitcnt vmcnt(10)
    s_barrier
    buffer_store_dword v43, v0, s[16:19], s0 offen sc1
    v_mfma_f32_16x16x32_bf16 v[184:187], v[152:155], v[68:71], v[184:187]
    ds_read_b64_tr_b16 v[168:169], v25 offset:3072
    v_mfma_f32_16x16x32_bf16 v[200:203], v[152:155], v[72:75], v[200:203]
    ds_read_b64_tr_b16 v[170:171], v25 offset:3584
    s_waitcnt lgkmcnt(4)
    v_mfma_f32_16x16x32_bf16 v[188:191], v[156:159], v[68:71], v[188:191]
    ds_read_b64_tr_b16 v[172:173], v26 offset:3072
    s_nop 0
    v_mfma_f32_16x16x32_bf16 v[204:207], v[156:159], v[72:75], v[204:207]
    ds_read_b64_tr_b16 v[174:175], v26 offset:3584
    v_mfma_f32_16x16x32_bf16 v[192:195], v[160:163], v[68:71], v[192:195]
    buffer_load_dwordx4 v19, s[12:15], s74 offen offset:3072 lds
    ds_read_b64_tr_b16 v[176:177], v27 offset:3072
    v_mfma_f32_16x16x32_bf16 v[208:211], v[160:163], v[72:75], v[208:211]
    ds_read_b64_tr_b16 v[178:179], v27 offset:3584
    s_waitcnt lgkmcnt(0)
    s_nop 0
    s_add_u32 m0, s72, 12288
    s_add_u32 s74, s34, s39
    buffer_load_dwordx4 v16, s[12:15], s74 offen offset:0 lds
    s_barrier
    v_mfma_f32_16x16x32_bf16 v[180:183], v[164:167], v[76:79], v[180:183]
    s_waitcnt vmcnt(10)
    ds_read_b128 a[128:131], v8 offset:0
    ds_read_b128 a[132:135], v9 offset:0
    ds_read_b128 a[136:139], v10 offset:0
    s_nop 0
    ds_read_b128 a[140:143], v11 offset:0
    ds_read_b64_tr_b16 v[148:149], v24 offset:16384
    v_mfma_f32_16x16x32_bf16 v[196:199], v[164:167], v[80:83], v[196:199]
    ds_read_b64_tr_b16 v[150:151], v24 offset:16896
    buffer_load_dwordx4 v17, s[12:15], s74 offen offset:1024 lds
    v_mfma_f32_16x16x32_bf16 v[184:187], v[168:171], v[76:79], v[184:187]
    ds_read_b64_tr_b16 v[152:153], v25 offset:16384
    v_mfma_f32_16x16x32_bf16 v[200:203], v[168:171], v[80:83], v[200:203]
    ds_read_b64_tr_b16 v[154:155], v25 offset:16896
    v_mfma_f32_16x16x32_bf16 v[188:191], v[172:175], v[76:79], v[188:191]
    ds_read_b64_tr_b16 v[156:157], v26 offset:16384
    v_mfma_f32_16x16x32_bf16 v[204:207], v[172:175], v[80:83], v[204:207]
    ds_read_b64_tr_b16 v[158:159], v26 offset:16896
    v_mfma_f32_16x16x32_bf16 v[192:195], v[176:179], v[76:79], v[192:195]
    buffer_load_dwordx4 v18, s[12:15], s74 offen offset:2048 lds
    ds_read_b64_tr_b16 v[160:161], v27 offset:16384
    v_mfma_f32_16x16x32_bf16 v[208:211], v[176:179], v[80:83], v[208:211]
    ds_read_b64_tr_b16 v[162:163], v27 offset:16896
    s_waitcnt lgkmcnt(4)
    v_mfma_f32_16x16x32_bf16 v[180:183], v[148:151], v[84:87], v[180:183]
    s_nop 0
    ds_read_b64_tr_b16 v[164:165], v24 offset:17408
    v_mfma_f32_16x16x32_bf16 v[196:199], v[148:151], v[88:91], v[196:199]
    ds_read_b64_tr_b16 v[166:167], v24 offset:17920
    v_mfma_f32_16x16x32_bf16 v[184:187], v[152:155], v[84:87], v[184:187]
    ds_read_b64_tr_b16 v[168:169], v25 offset:17408
    v_mfma_f32_16x16x32_bf16 v[200:203], v[152:155], v[88:91], v[200:203]
    buffer_load_dwordx4 v19, s[12:15], s74 offen offset:3072 lds
    ds_read_b64_tr_b16 v[170:171], v25 offset:17920
    s_waitcnt lgkmcnt(4)
    v_mfma_f32_16x16x32_bf16 v[188:191], v[156:159], v[84:87], v[188:191]
    ds_read_b64_tr_b16 v[172:173], v26 offset:17408
    v_mfma_f32_16x16x32_bf16 v[204:207], v[156:159], v[88:91], v[204:207]
    s_nop 0
    ds_read_b64_tr_b16 v[174:175], v26 offset:17920
    v_mfma_f32_16x16x32_bf16 v[192:195], v[160:163], v[84:87], v[192:195]
    ds_read_b64_tr_b16 v[176:177], v27 offset:17408
    v_mfma_f32_16x16x32_bf16 v[208:211], v[160:163], v[88:91], v[208:211]
    ds_read_b64_tr_b16 v[178:179], v27 offset:17920
    s_add_u32 m0, s72, 16384
    s_add_u32 s74, s35, s36
    buffer_load_dwordx4 v16, s[12:15], s74 offen offset:0 lds
    s_waitcnt lgkmcnt(4)
    v_mfma_f32_16x16x32_bf16 v[180:183], v[164:167], v[92:95], v[180:183]
    s_waitcnt vmcnt(10)
    ds_read_b128 a[144:147], v8 offset:4096
    ds_read_b128 a[148:151], v9 offset:4096
    s_nop 0
    ds_read_b128 a[152:155], v10 offset:4096
    ds_read_b128 a[156:159], v11 offset:4096
    ds_read_b64_tr_b16 v[148:149], v24 offset:18432
    v_mfma_f32_16x16x32_bf16 v[196:199], v[164:167], v[96:99], v[196:199]
    ds_read_b64_tr_b16 v[150:151], v24 offset:18944
    v_mfma_f32_16x16x32_bf16 v[184:187], v[168:171], v[92:95], v[184:187]
    ds_read_b64_tr_b16 v[152:153], v25 offset:18432
    v_mfma_f32_16x16x32_bf16 v[200:203], v[168:171], v[96:99], v[200:203]
    buffer_load_dwordx4 v17, s[12:15], s74 offen offset:1024 lds
    ds_read_b64_tr_b16 v[154:155], v25 offset:18944
    s_waitcnt lgkmcnt(8)
    v_mfma_f32_16x16x32_bf16 v[188:191], v[172:175], v[92:95], v[188:191]
    s_nop 0
    ds_read_b64_tr_b16 v[156:157], v26 offset:18432
    v_mfma_f32_16x16x32_bf16 v[204:207], v[172:175], v[96:99], v[204:207]
    ds_read_b64_tr_b16 v[158:159], v26 offset:18944
    v_mfma_f32_16x16x32_bf16 v[192:195], v[176:179], v[92:95], v[192:195]
    ds_read_b64_tr_b16 v[160:161], v27 offset:18432
    v_mfma_f32_16x16x32_bf16 v[208:211], v[176:179], v[96:99], v[208:211]
    ds_read_b64_tr_b16 v[162:163], v27 offset:18944
    buffer_load_dwordx4 v18, s[12:15], s74 offen offset:2048 lds
    s_waitcnt lgkmcnt(4)
    v_mfma_f32_16x16x32_bf16 v[180:183], v[148:151], v[100:103], v[180:183]
    ds_read_b64_tr_b16 v[164:165], v24 offset:19456
    v_mfma_f32_16x16x32_bf16 v[196:199], v[148:151], v[104:107], v[196:199]
    s_nop 0
    ds_read_b64_tr_b16 v[166:167], v24 offset:19968
    v_mfma_f32_16x16x32_bf16 v[184:187], v[152:155], v[100:103], v[184:187]
    ds_read_b64_tr_b16 v[168:169], v25 offset:19456
    v_mfma_f32_16x16x32_bf16 v[200:203], v[152:155], v[104:107], v[200:203]
    ds_read_b64_tr_b16 v[170:171], v25 offset:19968
    s_waitcnt lgkmcnt(4)
    v_mfma_f32_16x16x32_bf16 v[188:191], v[156:159], v[100:103], v[188:191]
    buffer_load_dwordx4 v19, s[12:15], s74 offen offset:3072 lds
    s_nop 0
    ds_read_b64_tr_b16 v[172:173], v26 offset:19456
    v_mfma_f32_16x16x32_bf16 v[204:207], v[156:159], v[104:107], v[204:207]
    ds_read_b64_tr_b16 v[174:175], v26 offset:19968
    v_mfma_f32_16x16x32_bf16 v[192:195], v[160:163], v[100:103], v[192:195]
    ds_read_b64_tr_b16 v[176:177], v27 offset:19456
    v_mfma_f32_16x16x32_bf16 v[208:211], v[160:163], v[104:107], v[208:211]
    ds_read_b64_tr_b16 v[178:179], v27 offset:19968
    s_waitcnt lgkmcnt(4)
    s_nop 0
    v_mfma_f32_16x16x32_bf16 v[180:183], v[164:167], v[108:111], v[180:183]
    v_mfma_f32_16x16x32_bf16 v[196:199], v[164:167], v[112:115], v[196:199]
    s_add_u32 m0, s72, 20480
    s_add_u32 s74, s35, s37
    s_nop 0
    buffer_load_dwordx4 v16, s[12:15], s74 offen offset:0 lds
    v_mfma_f32_16x16x32_bf16 v[184:187], v[168:171], v[108:111], v[184:187]
    v_mfma_f32_16x16x32_bf16 v[200:203], v[168:171], v[112:115], v[200:203]
    s_waitcnt lgkmcnt(0)
    s_nop 0
    v_mfma_f32_16x16x32_bf16 v[188:191], v[172:175], v[108:111], v[188:191]
    v_mfma_f32_16x16x32_bf16 v[204:207], v[172:175], v[112:115], v[204:207]
    v_mfma_f32_16x16x32_bf16 v[192:195], v[176:179], v[108:111], v[192:195]
    buffer_load_dwordx4 v17, s[12:15], s74 offen offset:1024 lds
    v_mfma_f32_16x16x32_bf16 v[208:211], v[176:179], v[112:115], v[208:211]
    buffer_load_dwordx4 v18, s[12:15], s74 offen offset:2048 lds
    buffer_load_dwordx4 v19, s[12:15], s74 offen offset:3072 lds
    s_xor_b32 s54, s49, 1
    s_lshl2_add_u32 s54, s54, s48
    s_mul_i32 s54, s54, 12
    s_add_u32 s54, s54, s52
    s_lshl_b32 s54, s54, 11
    s_add_u32 s60, s54, 8388608
    s_add_u32 s61, s54, 8389632
    s_nop 0
    v_pk_mul_f32 v[212:213], v[196:197], v[196:197]
    s_add_u32 m0, s72, 0
    s_add_u32 s74, s35, s38
    buffer_load_dwordx4 v16, s[12:15], s74 offen offset:0 lds
    v_pk_mul_f32 v[214:215], v[198:199], v[198:199]
    v_pk_mul_f32 v[216:217], v[200:201], v[200:201]
    v_pk_mul_f32 v[218:219], v[202:203], v[202:203]
    v_pk_fma_f32 v[212:213], v[212:213], s[68:69], v[36:37]
    v_pk_fma_f32 v[214:215], v[214:215], s[68:69], v[36:37]
    v_pk_fma_f32 v[216:217], v[216:217], s[68:69], v[36:37]
    v_pk_fma_f32 v[218:219], v[218:219], s[68:69], v[36:37]
    v_pk_mul_f32 v[212:213], v[212:213], v[196:197]
    v_pk_mul_f32 v[214:215], v[214:215], v[198:199]
    v_pk_mul_f32 v[216:217], v[216:217], v[200:201]
    buffer_load_dwordx4 v17, s[12:15], s74 offen offset:1024 lds
    v_pk_mul_f32 v[218:219], v[218:219], v[202:203]
    v_exp_f32 v212, v212
    v_exp_f32 v213, v213
    v_exp_f32 v214, v214
    v_exp_f32 v215, v215
    v_exp_f32 v216, v216
    v_exp_f32 v217, v217
    buffer_load_dwordx4 v18, s[12:15], s74 offen offset:2048 lds
    buffer_load_dword v49, v48, s[16:19], 0 offen sc1
    v_exp_f32 v218, v218
    v_exp_f32 v219, v219
    v_pk_add_f32 v[212:213], v[212:213], 1.0 op_sel_hi:[1,0]
    v_pk_add_f32 v[214:215], v[214:215], 1.0 op_sel_hi:[1,0]
    v_pk_add_f32 v[216:217], v[216:217], 1.0 op_sel_hi:[1,0]
    v_pk_add_f32 v[218:219], v[218:219], 1.0 op_sel_hi:[1,0]
    v_rcp_f32 v212, v212
    v_rcp_f32 v213, v213
    v_rcp_f32 v214, v214
    buffer_load_dwordx4 v19, s[12:15], s74 offen offset:3072 lds
    v_rcp_f32 v215, v215
    s_waitcnt vmcnt(17)
    ds_read_b128 a[160:163], v8 offset:8192
    ds_read_b128 a[164:167], v9 offset:8192
    ds_read_b128 a[168:171], v10 offset:8192
    s_nop 0
    ds_read_b128 a[172:175], v11 offset:8192
    s_waitcnt vmcnt(13)
    ds_read_b128 a[176:179], v8 offset:12288
    ds_read_b128 a[180:183], v9 offset:12288
    s_nop 0
    ds_read_b128 a[184:187], v10 offset:12288
    ds_read_b128 a[188:191], v11 offset:12288
    s_add_u32 m0, s72, 4096
    s_add_u32 s74, s35, s39
    s_nop 0
    buffer_load_dwordx4 v16, s[12:15], s74 offen offset:0 lds
    buffer_load_dwordx4 v17, s[12:15], s74 offen offset:1024 lds
    v_rcp_f32 v216, v216
    v_rcp_f32 v217, v217
    v_rcp_f32 v218, v218
    v_rcp_f32 v219, v219
    buffer_load_dwordx4 v18, s[12:15], s74 offen offset:2048 lds
    v_pk_mul_f32 v[196:197], v[196:197], v[212:213]
    v_pk_mul_f32 v[198:199], v[198:199], v[214:215]
    v_pk_mul_f32 v[200:201], v[200:201], v[216:217]
    v_pk_mul_f32 v[202:203], v[202:203], v[218:219]
    v_cvt_pk_bf16_f32 v92, v196, v197
    v_cvt_pk_bf16_f32 v93, v198, v199
    v_cvt_pk_bf16_f32 v94, v200, v201
    v_cvt_pk_bf16_f32 v95, v202, v203
    v_pk_mul_f32 v[212:213], v[204:205], v[204:205]
    v_pk_mul_f32 v[214:215], v[206:207], v[206:207]
    v_pk_mul_f32 v[216:217], v[208:209], v[208:209]
    v_pk_mul_f32 v[218:219], v[210:211], v[210:211]
    v_pk_fma_f32 v[212:213], v[212:213], s[68:69], v[36:37]
    buffer_load_dwordx4 v19, s[12:15], s74 offen offset:3072 lds
    v_pk_fma_f32 v[214:215], v[214:215], s[68:69], v[36:37]
    v_pk_fma_f32 v[216:217], v[216:217], s[68:69], v[36:37]
    v_pk_fma_f32 v[218:219], v[218:219], s[68:69], v[36:37]
    v_pk_mul_f32 v[212:213], v[212:213], v[204:205]
    v_pk_mul_f32 v[214:215], v[214:215], v[206:207]
    v_pk_mul_f32 v[216:217], v[216:217], v[208:209]
    v_pk_mul_f32 v[218:219], v[218:219], v[210:211]
    v_exp_f32 v212, v212
    v_exp_f32 v213, v213
    v_exp_f32 v214, v214
    v_exp_f32 v215, v215
    v_exp_f32 v216, v216
    v_exp_f32 v217, v217
    v_exp_f32 v218, v218
    v_exp_f32 v219, v219
    v_pk_add_f32 v[212:213], v[212:213], 1.0 op_sel_hi:[1,0]
    v_pk_add_f32 v[214:215], v[214:215], 1.0 op_sel_hi:[1,0]
    v_pk_add_f32 v[216:217], v[216:217], 1.0 op_sel_hi:[1,0]
    v_pk_add_f32 v[218:219], v[218:219], 1.0 op_sel_hi:[1,0]
    v_rcp_f32 v212, v212
    v_rcp_f32 v213, v213
    v_rcp_f32 v214, v214
    v_rcp_f32 v215, v215
    v_rcp_f32 v216, v216
    v_rcp_f32_e64 v217, v217
    s_waitcnt vmcnt(13)
    ds_read_b128 a[192:195], v8 offset:16384
    ds_read_b128 a[196:199], v9 offset:16384
    ds_read_b128 a[200:203], v10 offset:16384
    ds_read_b128 a[204:207], v11 offset:16384
    v_rcp_f32 v218, v218
    v_rcp_f32 v219, v219
    v_pk_mul_f32 v[204:205], v[204:205], v[212:213]
    v_pk_mul_f32 v[206:207], v[206:207], v[214:215]
    v_pk_mul_f32 v[208:209], v[208:209], v[216:217]
    v_pk_mul_f32 v[210:211], v[210:211], v[218:219]
    v_cvt_pk_bf16_f32 v96, v204, v205
    v_cvt_pk_bf16_f32 v97, v206, v207
    v_cvt_pk_bf16_f32 v98, v208, v209
    v_cvt_pk_bf16_f32 v99, v210, v211
    v_pk_mul_f32 v[212:213], v[180:181], v[180:181]
    s_waitcnt vmcnt(5)
    v_cmp_ne_u32 vcc, v49, v43
    s_cbranch_vccnz L_slow2
L_ok2:
    buffer_load_dwordx4 v[116:119], v3, s[16:19], s40 offen offset:0 sc1
    buffer_load_dwordx4 v[120:123], v3, s[16:19], s40 offen offset:1024 sc1
    s_nop 0
    buffer_load_dwordx4 v[124:127], v3, s[16:19], s40 offen offset:2048 sc1
    v_pk_mul_f32 v[214:215], v[182:183], v[182:183]
    v_pk_mul_f32 v[216:217], v[184:185], v[184:185]
    v_pk_mul_f32 v[218:219], v[186:187], v[186:187]
    v_pk_fma_f32 v[212:213], v[212:213], s[68:69], v[36:37]
    v_pk_fma_f32 v[214:215], v[214:215], s[68:69], v[36:37]
    v_pk_fma_f32 v[216:217], v[216:217], s[68:69], v[36:37]
    v_pk_fma_f32 v[218:219], v[218:219], s[68:69], v[36:37]
    v_pk_mul_f32 v[212:213], v[212:213], v[180:181]
    v_pk_mul_f32 v[214:215], v[214:215], v[182:183]
    v_pk_mul_f32 v[216:217], v[216:217], v[184:185]
    buffer_load_dwordx4 v[128:131], v3, s[16:19], s40 offen offset:3072 sc1
    v_pk_mul_f32 v[218:219], v[218:219], v[186:187]
    v_exp_f32 v212, v212
    v_exp_f32 v213, v213
    v_exp_f32 v214, v214
    v_exp_f32 v215, v215
    v_exp_f32 v216, v216
    v_exp_f32 v217, v217
    buffer_load_dwordx4 v[132:135], v3, s[16:19], s41 offen offset:0 sc1
    v_exp_f32 v218, v218
    v_exp_f32 v219, v219
    v_pk_add_f32 v[212:213], v[212:213], 1.0 op_sel_hi:[1,0]
    v_pk_add_f32 v[214:215], v[214:215], 1.0 op_sel_hi:[1,0]
    v_pk_add_f32 v[216:217], v[216:217], 1.0 op_sel_hi:[1,0]
    v_pk_add_f32 v[218:219], v[218:219], 1.0 op_sel_hi:[1,0]
    v_rcp_f32 v212, v212
    v_rcp_f32 v213, v213
    v_rcp_f32_e64 v214, v214
    buffer_load_dwordx4 v[136:139], v3, s[16:19], s41 offen offset:1024 sc1
    ds_read_b128 a[208:211], v8 offset:20480
    ds_read_b128 a[212:215], v9 offset:20480
    ds_read_b128 a[216:219], v10 offset:20480
    ds_read_b128 a[220:223], v11 offset:20480
    v_rcp_f32 v215, v215
    v_rcp_f32 v216, v216
    v_rcp_f32 v217, v217
    v_rcp_f32 v218, v218
    buffer_load_dwordx4 v[140:143], v3, s[16:19], s41 offen offset:2048 sc1
    v_rcp_f32_e64 v219, v219
    v_pk_mul_f32 v[180:181], v[180:181], v[212:213]
    v_pk_mul_f32 v[182:183], v[182:183], v[214:215]
    v_pk_mul_f32 v[184:185], v[184:185], v[216:217]
    v_pk_mul_f32 v[186:187], v[186:187], v[218:219]
    v_pk_mul_f32 v[212:213], v[188:189], v[188:189]
    v_pk_mul_f32 v[214:215], v[190:191], v[190:191]
    v_pk_mul_f32 v[216:217], v[192:193], v[192:193]
    v_pk_mul_f32 v[218:219], v[194:195], v[194:195]
    v_pk_fma_f32 v[212:213], v[212:213], s[68:69], v[36:37]
    v_pk_fma_f32 v[214:215], v[214:215], s[68:69], v[36:37]
    buffer_load_dwordx4 v[144:147], v3, s[16:19], s41 offen offset:3072 sc1
    v_pk_fma_f32 v[216:217], v[216:217], s[68:69], v[36:37]
    v_pk_fma_f32 v[218:219], v[218:219], s[68:69], v[36:37]
    v_pk_mul_f32 v[212:213], v[212:213], v[188:189]
    v_pk_mul_f32 v[214:215], v[214:215], v[190:191]
    v_pk_mul_f32 v[216:217], v[216:217], v[192:193]
    v_pk_mul_f32 v[218:219], v[218:219], v[194:195]
    v_exp_f32 v212, v212
    v_exp_f32 v213, v213
    v_exp_f32 v214, v214
    v_exp_f32 v215, v215
    buffer_load_dwordx4 v[148:151], v3, s[16:19], s42 offen offset:0 sc1
    v_exp_f32 v216, v216
    v_exp_f32 v217, v217
    v_exp_f32 v218, v218
    v_exp_f32 v219, v219
    v_pk_add_f32 v[212:213], v[212:213], 1.0 op_sel_hi:[1,0]
    v_pk_add_f32 v[214:215], v[214:215], 1.0 op_sel_hi:[1,0]
    v_pk_add_f32 v[216:217], v[216:217], 1.0 op_sel_hi:[1,0]
    v_pk_add_f32 v[218:219], v[218:219], 1.0 op_sel_hi:[1,0]
    buffer_load_dwordx4 v[152:155], v3, s[16:19], s42 offen offset:1024 sc1
    v_rcp_f32 v212, v212
    v_rcp_f32 v213, v213
    v_rcp_f32 v214, v214
    s_waitcnt vmcnt(14)
    ds_read_b128 a[224:227], v8 offset:0
    ds_read_b128 a[228:231], v9 offset:0
    ds_read_b128 a[232:235], v10 offset:0
    ds_read_b128 a[236:239], v11 offset:0
    v_rcp_f32 v215, v215
    v_rcp_f32 v216, v216
    buffer_load_dwordx4 v[156:159], v3, s[16:19], s42 offen offset:2048 sc1
    v_rcp_f32 v217, v217
    v_rcp_f32 v218, v218
    v_rcp_f32_e64 v219, v219
    v_pk_mul_f32 v[188:189], v[188:189], v[212:213]
    v_pk_mul_f32 v[190:191], v[190:191], v[214:215]
    v_pk_mul_f32 v[192:193], v[192:193], v[216:217]
    v_pk_mul_f32 v[194:195], v[194:195], v[218:219]
    buffer_load_dwordx4 v[160:163], v3, s[16:19], s42 offen offset:3072 sc1
    buffer_load_dwordx4 v[164:167], v3, s[16:19], s43 offen offset:0 sc1
    buffer_load_dwordx4 v[168:171], v3, s[16:19], s43 offen offset:1024 sc1
    v_mov_b32 v32, 1073741824
    v_mov_b32 v33, 1073741824
    v_mov_b32 v34, v2
    v_mov_b32_e64 v35, v2
    s_waitcnt vmcnt(14)
    ds_read_b128 a[240:243], v8 offset:4096
    ds_read_b128 a[244:247], v9 offset:4096
    ds_read_b128 a[248:251], v10 offset:4096
    ds_read_b128 a[252:255], v11 offset:4096
    s_waitcnt lgkmcnt(0)
L_join:
    v_mov_b32 v12, v40
    v_mov_b32 v13, v40
    v_mov_b32 v14, v40
    v_mov_b32_e64 v15, v40
    s_and_b32 s52, s50, 3
    s_waitcnt vmcnt(12)
    v_mfma_f32_16x16x32_bf16 v[76:79], v[116:119], a[48:51], 0
    buffer_load_dwordx4 v[172:175], v3, s[16:19], s43 offen offset:2048 sc1
    v_mfma_f32_16x16x32_bf16 v[80:83], v[120:123], a[48:51], 0
    v_add_u32 v8, 32768, v2
    v_add_u32 v9, 65536, v2
    v_mfma_f32_16x16x32_bf16 v[72:75], v[120:123], a[32:35], 0
    buffer_load_dwordx4 v[176:179], v3, s[16:19], s43 offen offset:3072 sc1
    v_mfma_f32_16x16x32_bf16 v[68:71], v[116:119], a[32:35], 0
    s_add_u32 s54, s50, 2
    s_and_b32 s54, s54, 7
    v_mfma_f32_16x16x32_bf16 v[60:63], v[116:119], a[16:19], 0
    buffer_load_dwordx4 v[196:199], v3, s[16:19], s44 offen offset:0 sc1
    v_mfma_f32_16x16x32_bf16 v[64:67], v[120:123], a[16:19], 0
    s_lshl_b32 s54, s54, 10
    s_add_u32 s33, s77, s54
    v_mfma_f32_16x16x32_bf16 v[56:59], v[120:123], a[0:3], v[12:15]
    buffer_load_dwordx4 v[200:203], v3, s[16:19], s44 offen offset:1024 sc1
    v_mfma_f32_16x16x32_bf16 v[52:55], v[116:119], a[0:3], v[12:15]
    s_add_u32 s54, s50, 4
    s_waitcnt vmcnt(14)
    v_mfma_f32_16x16x32_bf16 v[76:79], v[124:127], a[52:55], v[76:79]
    buffer_load_dwordx4 v[204:207], v3, s[16:19], s44 offen offset:2048 sc1
    v_mfma_f32_16x16x32_bf16 v[80:83], v[128:131], a[52:55], v[80:83]
    buffer_store_dwordx4 v[92:95], v34, s[16:19], s60 offen sc1
    v_mfma_f32_16x16x32_bf16 v[72:75], v[128:131], a[36:39], v[72:75]
    buffer_load_dwordx4 v[208:211], v3, s[16:19], s44 offen offset:3072 sc1
    v_mfma_f32_16x16x32_bf16 v[68:71], v[124:127], a[36:39], v[68:71]
    s_and_b32 s54, s54, 7
    s_lshl_b32 s54, s54, 10
    v_mfma_f32_16x16x32_bf16 v[60:63], v[124:127], a[20:23], v[60:63]
    buffer_load_dwordx4 v[116:119], v3, s[16:19], s45 offen offset:0 sc1
    v_mfma_f32_16x16x32_bf16 v[64:67], v[128:131], a[20:23], v[64:67]
    s_add_u32 s34, s77, s54
    s_add_u32 s54, s50, 6
    v_mfma_f32_16x16x32_bf16 v[56:59], v[128:131], a[4:7], v[56:59]
    s_and_b32 s54, s54, 7
    s_lshl_b32 s54, s54, 10
    v_mfma_f32_16x16x32_bf16 v[52:55], v[124:127], a[4:7], v[52:55]
    s_add_u32 s35, s77, s54
    s_waitcnt vmcnt(16)
    v_mfma_f32_16x16x32_bf16 v[76:79], v[132:135], a[56:59], v[76:79]
    buffer_load_dwordx4 v[120:123], v3, s[16:19], s45 offen offset:1024 sc1
    v_mfma_f32_16x16x32_bf16 v[80:83], v[136:139], a[56:59], v[80:83]
    s_add_u32 s54, s50, 1
    s_and_b32 s54, s54, 7
    v_mfma_f32_16x16x32_bf16 v[72:75], v[136:139], a[40:43], v[72:75]
    s_lshl_b32 s54, s54, 10
    s_add_u32 s36, s77, s54
    v_mfma_f32_16x16x32_bf16 v[68:71], v[132:135], a[40:43], v[68:71]
    s_add_u32 s54, s50, 3
    s_and_b32 s54, s54, 7
    v_mfma_f32_16x16x32_bf16 v[60:63], v[132:135], a[24:27], v[60:63]
    buffer_load_dwordx4 v[124:127], v3, s[16:19], s45 offen offset:2048 sc1
    v_mfma_f32_16x16x32_bf16 v[64:67], v[136:139], a[24:27], v[64:67]
    s_lshl_b32 s54, s54, 10
    s_add_u32 s37, s77, s54
    v_mfma_f32_16x16x32_bf16 v[56:59], v[136:139], a[8:11], v[56:59]
    s_add_u32 s54, s50, 5
    s_and_b32 s54, s54, 7
    v_mfma_f32_16x16x32_bf16 v[52:55], v[132:135], a[8:11], v[52:55]
    s_lshl_b32 s54, s54, 10
    s_waitcnt vmcnt(16)
    v_mfma_f32_16x16x32_bf16 v[76:79], v[140:143], a[60:63], v[76:79]
    buffer_load_dwordx4 v[128:131], v3, s[16:19], s45 offen offset:3072 sc1
    v_mfma_f32_16x16x32_bf16 v[80:83], v[144:147], a[60:63], v[80:83]
    buffer_store_dwordx4 v[96:99], v35, s[16:19], s61 offen sc1
    v_mfma_f32_16x16x32_bf16 v[72:75], v[144:147], a[44:47], v[72:75]
    s_add_u32 s38, s77, s54
    s_add_u32 s54, s50, 7
    v_mfma_f32_16x16x32_bf16 v[68:71], v[140:143], a[44:47], v[68:71]
    s_and_b32 s54, s54, 7
    s_lshl_b32 s54, s54, 10
    v_mfma_f32_16x16x32_bf16 v[60:63], v[140:143], a[28:31], v[60:63]
    buffer_load_dwordx4 v[132:135], v3, s[16:19], s46 offen offset:0 sc1
    v_mfma_f32_16x16x32_bf16 v[64:67], v[144:147], a[28:31], v[64:67]
    s_add_u32 s39, s77, s54
    s_lshl1_add_u32 s54, s48, s50
    v_mfma_f32_16x16x32_bf16 v[56:59], v[144:147], a[12:15], v[56:59]
    s_add_u32 s54, s54, 0
    s_and_b32 s54, s54, 7
    v_mfma_f32_16x16x32_bf16 v[52:55], v[140:143], a[12:15], v[52:55]
    s_and_b32 s64, s49, 1
    s_waitcnt vmcnt(17)
    v_mfma_f32_16x16x32_bf16 v[76:79], v[148:151], a[112:115], v[76:79]
    buffer_load_dwordx4 v[136:139], v3, s[16:19], s46 offen offset:1024 sc1
    v_mfma_f32_16x16x32_bf16 v[80:83], v[152:155], a[112:115], v[80:83]
    s_and_b32 s56, s54, 3
    s_lshl2_add_u32 s63, s64, s56
    v_mfma_f32_16x16x32_bf16 v[72:75], v[152:155], a[96:99], v[72:75]
    s_lshl_b32 s63, s63, 2
    s_lshr_b32 s63, 0x4a86a420, s63
    s_nop 0
    v_mfma_f32_16x16x32_bf16 v[68:71], v[148:151], a[96:99], v[68:71]
    s_and_b32 s63, s63, 15
    s_mul_i32 s64, s64, -6
    v_mfma_f32_16x16x32_bf16 v[60:63], v[148:151], a[80:83], v[60:63]
    buffer_load_dwordx4 v[140:143], v3, s[16:19], s46 offen offset:2048 sc1
    v_mfma_f32_16x16x32_bf16 v[64:67], v[152:155], a[80:83], v[64:67]
    s_add_u32 s64, s64, s56
    s_lshr_b32 s56, s54, 2
    v_mfma_f32_16x16x32_bf16 v[56:59], v[152:155], a[64:67], v[56:59]
    s_mul_i32 s56, s56, 12
    s_add_u32 s63, s63, s56
    v_mfma_f32_16x16x32_bf16 v[52:55], v[148:151], a[64:67], v[52:55]
    s_add_u32 s64, s64, s56
    s_waitcnt vmcnt(17)
    v_mfma_f32_16x16x32_bf16 v[76:79], v[156:159], a[116:119], v[76:79]
    buffer_load_dwordx4 v[144:147], v3, s[16:19], s46 offen offset:3072 sc1
    v_mfma_f32_16x16x32_bf16 v[80:83], v[160:163], a[116:119], v[80:83]
    s_add_u32 s64, s64, 6
    s_lshl1_add_u32 s54, s48, s50
    v_mfma_f32_16x16x32_bf16 v[72:75], v[160:163], a[100:103], v[72:75]
    s_add_u32 s54, s54, 1
    s_and_b32 s54, s54, 7
    v_mfma_f32_16x16x32_bf16 v[68:71], v[156:159], a[100:103], v[68:71]
    s_and_b32 s66, s49, 1
    s_and_b32 s56, s54, 3
    v_mfma_f32_16x16x32_bf16 v[60:63], v[156:159], a[84:87], v[60:63]
    buffer_load_dwordx4 v[148:151], v3, s[16:19], s47 offen offset:0 sc1
    v_mfma_f32_16x16x32_bf16 v[64:67], v[160:163], a[84:87], v[64:67]
    s_lshl2_add_u32 s65, s66, s56
    s_lshl_b32 s65, s65, 2
    v_mfma_f32_16x16x32_bf16 v[56:59], v[160:163], a[68:71], v[56:59]
    s_lshr_b32 s65, 0x4a86a420, s65
    s_and_b32 s65, s65, 15
    v_mfma_f32_16x16x32_bf16 v[52:55], v[156:159], a[68:71], v[52:55]
    s_mul_i32 s66, s66, -6
    s_waitcnt vmcnt(17)
    v_mfma_f32_16x16x32_bf16 v[76:79], v[164:167], a[120:123], v[76:79]
    s_nop 0
    buffer_load_dwordx4 v[152:155], v3, s[16:19], s47 offen offset:1024 sc1
    v_mfma_f32_16x16x32_bf16 v[80:83], v[168:171], a[120:123], v[80:83]
    s_add_u32 s66, s66, s56
    s_lshr_b32 s56, s54, 2
    v_mfma_f32_16x16x32_bf16 v[72:75], v[168:171], a[104:107], v[72:75]
    s_mul_i32 s56, s56, 12
    s_add_u32 s65, s65, s56
    v_mfma_f32_16x16x32_bf16 v[68:71], v[164:167], a[104:107], v[68:71]
    s_add_u32 s66, s66, s56
    s_add_u32 s66, s66, 6
    v_mfma_f32_16x16x32_bf16 v[60:63], v[164:167], a[88:91], v[60:63]
    buffer_load_dwordx4 v[156:159], v3, s[16:19], s47 offen offset:2048 sc1
    v_mfma_f32_16x16x32_bf16 v[64:67], v[168:171], a[88:91], v[64:67]
    s_mul_i32 s54, s50, 122880
    s_add_u32 s54, s54, 524288
    v_mfma_f32_16x16x32_bf16 v[56:59], v[168:171], a[72:75], v[56:59]
    s_mul_i32 s63, s63, 5120
    s_add_u32 s63, s63, s54
    v_mfma_f32_16x16x32_bf16 v[52:55], v[164:167], a[72:75], v[52:55]
    s_nop 0
    s_mul_i32 s64, s64, 5120
    s_waitcnt vmcnt(17)
    v_mfma_f32_16x16x32_bf16 v[76:79], v[172:175], a[124:127], v[76:79]
    buffer_load_dwordx4 v[160:163], v3, s[16:19], s47 offen offset:3072 sc1
    s_nop 0
    v_mfma_f32_16x16x32_bf16 v[80:83], v[176:179], a[124:127], v[80:83]
    s_add_u32 s64, s64, s54
    s_mul_i32 s65, s65, 5120
    v_mfma_f32_16x16x32_bf16 v[72:75], v[176:179], a[108:111], v[72:75]
    s_add_u32 s65, s65, s54
    s_mul_i32 s66, s66, 5120
    v_mfma_f32_16x16x32_bf16 v[68:71], v[172:175], a[108:111], v[68:71]
    s_add_u32 s66, s66, s54
    s_lshl2_add_u32 s54, s49, s48
    v_mfma_f32_16x16x32_bf16 v[60:63], v[172:175], a[92:95], v[60:63]
    buffer_load_dwordx4 v[164:167], v47, s[16:19], s40 offen offset:0 sc1
    v_mfma_f32_16x16x32_bf16 v[64:67], v[176:179], a[92:95], v[64:67]
    s_mul_i32 s54, s54, 20480
    s_lshr_b32 s56, s50, 2
    s_nop 0
    v_mfma_f32_16x16x32_bf16 v[56:59], v[176:179], a[76:79], v[56:59]
    s_mul_i32 s56, s56, 640
    s_add_u32 s54, s54, s56
    v_mfma_f32_16x16x32_bf16 v[52:55], v[172:175], a[76:79], v[52:55]
    s_and_b32 s56, s50, 3
    s_waitcnt vmcnt(17)
    v_mfma_f32_16x16x32_bf16 v[76:79], v[196:199], a[176:179], v[76:79]
    buffer_load_dwordx4 v[168:171], v47, s[16:19], s40 offen offset:1024 sc1
    v_mfma_f32_16x16x32_bf16 v[80:83], v[200:203], a[176:179], v[80:83]
    v_lshrrev_b32 v4, 4, v1
    v_mul_u32_u24 v4, 5120, v4
    v_mfma_f32_16x16x32_bf16 v[72:75], v[200:203], a[160:163], v[72:75]
    v_add_u32_e64 v4, s54, v4
    v_bfe_u32 v5, v1, 3, 1
    v_mfma_f32_16x16x32_bf16 v[68:71], v[196:199], a[160:163], v[68:71]
    v_mul_u32_u24 v5, 1280, v5
    v_and_b32 v6, 0x70, v2
    v_mfma_f32_16x16x32_bf16 v[60:63], v[196:199], a[144:147], v[60:63]
    buffer_load_dwordx4 v[172:175], v47, s[16:19], s40 offen offset:2048 sc1
    v_mfma_f32_16x16x32_bf16 v[64:67], v[200:203], a[144:147], v[64:67]
    v_add3_u32 v5, v4, v5, v6
    v_lshl_add_u32 v38, s56, 7, v5
    v_mfma_f32_16x16x32_bf16 v[56:59], v[200:203], a[128:131], v[56:59]
    v_bfe_u32 v5, v1, 2, 2
    v_mul_u32_u24 v5, 1280, v5
    v_mfma_f32_16x16x32_bf16 v[52:55], v[196:199], a[128:131], v[52:55]
    v_and_b32 v6, 3, v1
    s_waitcnt vmcnt(16)
    v_mfma_f32_16x16x32_bf16 v[76:79], v[204:207], a[180:183], v[76:79]
    buffer_load_dwordx4 v[176:179], v47, s[16:19], s40 offen offset:3072 sc1
    v_mfma_f32_16x16x32_bf16 v[80:83], v[208:211], a[180:183], v[80:83]
    v_lshl_add_u32 v5, v6, 3, v5
    v_lshl_add_u32 v5, s56, 5, v5
    v_mfma_f32_16x16x32_bf16 v[72:75], v[208:211], a[164:167], v[72:75]
    v_add_u32 v39, v4, v5
    v_and_b32 v5, 60, v1
    v_mfma_f32_16x16x32_bf16 v[68:71], v[204:207], a[164:167], v[68:71]
    v_lshl_add_u32 v41, v6, 6, v5
    v_add_u32 v51, 61440, v2
    v_mfma_f32_16x16x32_bf16 v[60:63], v[204:207], a[148:151], v[60:63]
    buffer_load_dwordx4 v[196:199], v47, s[16:19], s41 offen offset:0 sc1
    v_mfma_f32_16x16x32_bf16 v[64:67], v[208:211], a[148:151], v[64:67]
    v_bfe_u32 v4, v1, 1, 2
    v_mul_u32_u24 v4, 1040, v4
    v_mfma_f32_16x16x32_bf16 v[56:59], v[208:211], a[132:135], v[56:59]
    v_and_b32 v5, 0x300, v2
    v_and_b32_e64 v6, 1, v1
    v_mfma_f32_16x16x32_bf16 v[52:55], v[204:207], a[132:135], v[52:55]
    v_lshl_add_u32 v5, v6, 7, v5
    s_waitcnt vmcnt(16)
    v_mfma_f32_16x16x32_bf16 v[76:79], v[116:119], a[184:187], v[76:79]
    buffer_load_dwordx4 v[200:203], v47, s[16:19], s41 offen offset:1024 sc1
    s_nop 0
    v_mfma_f32_16x16x32_bf16 v[80:83], v[120:123], a[184:187], v[80:83]
    s_waitcnt vmcnt(14)
    s_barrier
    buffer_store_dword v43, v0, s[16:19], s81 offen sc1
    v_mfma_f32_16x16x32_bf16 v[72:75], v[120:123], a[168:171], v[72:75]
    v_bfe_u32 v6, v1, 3, 1
    v_lshl_add_u32 v5, v6, 6, v5
    v_mfma_f32_16x16x32_bf16 v[68:71], v[116:119], a[168:171], v[68:71]
    v_add_u32 v16, v4, v5
    v_xor_b32 v17, 16, v16
    v_mfma_f32_16x16x32_bf16 v[60:63], v[116:119], a[152:155], v[60:63]
    buffer_load_dwordx4 v[204:207], v47, s[16:19], s41 offen offset:2048 sc1
    v_mfma_f32_16x16x32_bf16 v[64:67], v[120:123], a[152:155], v[64:67]
    v_xor_b32 v18, 32, v16
    v_xor_b32 v19, 48, v16
    v_mfma_f32_16x16x32_bf16 v[56:59], v[120:123], a[136:139], v[56:59]
    v_add_u32 v20, 61440, v16
    v_add_u32 v21, 61440, v17
    v_mfma_f32_16x16x32_bf16 v[52:55], v[116:119], a[136:139], v[52:55]
    v_add_u32 v22, 61440, v18
    v_mfma_f32_16x16x32_bf16 v[76:79], v[124:127], a[188:191], v[76:79]
    buffer_load_dwordx4 v[208:211], v47, s[16:19], s41 offen offset:3072 sc1
    v_mfma_f32_16x16x32_bf16 v[80:83], v[128:131], a[188:191], v[80:83]
    v_add_u32 v23, 61440, v19
    v_mfma_f32_16x16x32_bf16 v[72:75], v[128:131], a[172:175], v[72:75]
    v_mfma_f32_16x16x32_bf16 v[68:71], v[124:127], a[172:175], v[68:71]
    v_mfma_f32_16x16x32_bf16 v[60:63], v[124:127], a[156:159], v[60:63]
    buffer_load_dwordx4 v[116:119], v47, s[16:19], s42 offen offset:0 sc1
    v_mfma_f32_16x16x32_bf16 v[64:67], v[128:131], a[156:159], v[64:67]
    v_mfma_f32_16x16x32_bf16 v[56:59], v[128:131], a[140:143], v[56:59]
    v_mfma_f32_16x16x32_bf16 v[52:55], v[124:127], a[140:143], v[52:55]
    s_waitcnt vmcnt(16)
    v_mfma_f32_16x16x32_bf16 v[76:79], v[132:135], a[240:243], v[76:79]
    buffer_load_dwordx4 v[120:123], v47, s[16:19], s42 offen offset:1024 sc1
    v_mfma_f32_16x16x32_bf16 v[80:83], v[136:139], a[240:243], v[80:83]
    s_nop 0
    v_mfma_f32_16x16x32_bf16 v[72:75], v[136:139], a[224:227], v[72:75]
    v_mfma_f32_16x16x32_bf16 v[68:71], v[132:135], a[224:227], v[68:71]
    v_mfma_f32_16x16x32_bf16 v[60:63], v[132:135], a[208:211], v[60:63]
    buffer_load_dwordx4 v[124:127], v47, s[16:19], s42 offen offset:2048 sc1
    v_mfma_f32_16x16x32_bf16 v[64:67], v[136:139], a[208:211], v[64:67]
    v_mfma_f32_16x16x32_bf16 v[56:59], v[136:139], a[192:195], v[56:59]
    v_mfma_f32_16x16x32_bf16 v[52:55], v[132:135], a[192:195], v[52:55]
    s_waitcnt vmcnt(16)
    s_nop 0
    v_mfma_f32_16x16x32_bf16 v[76:79], v[140:143], a[244:247], v[76:79]
    buffer_load_dwordx4 v[128:131], v47, s[16:19], s42 offen offset:3072 sc1
    v_mfma_f32_16x16x32_bf16 v[80:83], v[144:147], a[244:247], v[80:83]
    v_mfma_f32_16x16x32_bf16 v[72:75], v[144:147], a[228:231], v[72:75]
    v_mfma_f32_16x16x32_bf16 v[68:71], v[140:143], a[228:231], v[68:71]
    v_mfma_f32_16x16x32_bf16 v[60:63], v[140:143], a[212:215], v[60:63]
    buffer_load_dwordx4 v[132:135], v47, s[16:19], s43 offen offset:0 sc1
    v_mfma_f32_16x16x32_bf16 v[64:67], v[144:147], a[212:215], v[64:67]
    v_mfma_f32_16x16x32_bf16 v[56:59], v[144:147], a[196:199], v[56:59]
    v_mfma_f32_16x16x32_bf16 v[52:55], v[140:143], a[196:199], v[52:55]
    s_waitcnt vmcnt(16)
    v_mfma_f32_16x16x32_bf16 v[76:79], v[148:151], a[248:251], v[76:79]
    s_nop 0
    buffer_load_dwordx4 v[136:139], v47, s[16:19], s43 offen offset:1024 sc1
    v_mfma_f32_16x16x32_bf16 v[80:83], v[152:155], a[248:251], v[80:83]
    v_mfma_f32_16x16x32_bf16 v[72:75], v[152:155], a[232:235], v[72:75]
    v_mfma_f32_16x16x32_bf16 v[68:71], v[148:151], a[232:235], v[68:71]
    v_mfma_f32_16x16x32_bf16 v[60:63], v[148:151], a[216:219], v[60:63]
    buffer_load_dwordx4 v[140:143], v47, s[16:19], s43 offen offset:2048 sc1
    v_mfma_f32_16x16x32_bf16 v[64:67], v[152:155], a[216:219], v[64:67]
    v_mfma_f32_16x16x32_bf16 v[56:59], v[152:155], a[200:203], v[56:59]
    v_mfma_f32_16x16x32_bf16 v[52:55], v[148:151], a[200:203], v[52:55]
    s_waitcnt vmcnt(16)
    v_mfma_f32_16x16x32_bf16 v[76:79], v[156:159], a[252:255], v[76:79]
    buffer_load_dwordx4 v[144:147], v47, s[16:19], s43 offen offset:3072 sc1
    s_nop 0
    v_mfma_f32_16x16x32_bf16 v[80:83], v[160:163], a[252:255], v[80:83]
    v_mfma_f32_16x16x32_bf16 v[72:75], v[160:163], a[236:239], v[72:75]
    v_mfma_f32_16x16x32_bf16 v[68:71], v[156:159], a[236:239], v[68:71]
    v_mfma_f32_16x16x32_bf16 v[60:63], v[156:159], a[220:223], v[60:63]
    buffer_load_dwordx4 v[148:151], v47, s[16:19], s44 offen offset:0 sc1
    v_mfma_f32_16x16x32_bf16 v[64:67], v[160:163], a[220:223], v[64:67]
    v_mfma_f32_16x16x32_bf16 v[56:59], v[160:163], a[204:207], v[56:59]
    v_mfma_f32_16x16x32_bf16 v[52:55], v[156:159], a[204:207], v[52:55]
    s_waitcnt vmcnt(16)
    v_mfma_f32_16x16x32_bf16 v[108:111], v[164:167], a[48:51], 0
    buffer_load_dwordx4 v[152:155], v47, s[16:19], s44 offen offset:1024 sc1
    v_mfma_f32_16x16x32_bf16 v[112:115], v[168:171], a[48:51], 0
    s_nop 0
    v_mfma_f32_16x16x32_bf16 v[104:107], v[168:171], a[32:35], 0
    v_mfma_f32_16x16x32_bf16 v[100:103], v[164:167], a[32:35], 0
    ds_write_b128 v28, v[76:79] offset:28672
    v_mfma_f32_16x16x32_bf16 v[92:95], v[164:167], a[16:19], 0
    buffer_load_dwordx4 v[156:159], v47, s[16:19], s44 offen offset:2048 sc1
    v_mfma_f32_16x16x32_bf16 v[96:99], v[168:171], a[16:19], 0
    v_mfma_f32_16x16x32_bf16 v[88:91], v[168:171], a[0:3], v[12:15]
    v_mfma_f32_16x16x32_bf16 v[84:87], v[164:167], a[0:3], v[12:15]
    s_waitcnt vmcnt(16)
    v_mfma_f32_16x16x32_bf16 v[108:111], v[172:175], a[52:55], v[108:111]
    buffer_load_dwordx4 v[160:163], v47, s[16:19], s44 offen offset:3072 sc1
    v_mfma_f32_16x16x32_bf16 v[112:115], v[176:179], a[52:55], v[112:115]
    s_nop 0
    ds_write_b128 v28, v[80:83] offset:29696
    v_mfma_f32_16x16x32_bf16 v[104:107], v[176:179], a[36:39], v[104:107]
    v_mfma_f32_16x16x32_bf16 v[100:103], v[172:175], a[36:39], v[100:103]
    v_mfma_f32_16x16x32_bf16 v[92:95], v[172:175], a[20:23], v[92:95]
    buffer_load_dwordx4 v[164:167], v47, s[16:19], s45 offen offset:0 sc1
    v_mfma_f32_16x16x32_bf16 v[96:99], v[176:179], a[20:23], v[96:99]
    v_mfma_f32_16x16x32_bf16 v[88:91], v[176:179], a[4:7], v[88:91]
    ds_write_b128 v28, v[68:71] offset:26624
    v_mfma_f32_16x16x32_bf16 v[84:87], v[172:175], a[4:7], v[84:87]
    s_waitcnt vmcnt(16)
    v_mfma_f32_16x16x32_bf16 v[108:111], v[196:199], a[56:59], v[108:111]
    buffer_load_dwordx4 v[168:171], v47, s[16:19], s45 offen offset:1024 sc1
    s_nop 0
    v_mfma_f32_16x16x32_bf16 v[112:115], v[200:203], a[56:59], v[112:115]
    s_cmp_eq_u32 s52, 3
    s_cbranch_scc1 L_pollA
L_pollAr:
    v_mfma_f32_16x16x32_bf16 v[104:107], v[200:203], a[40:43], v[104:107]
    v_mfma_f32_16x16x32_bf16 v[100:103], v[196:199], a[40:43], v[100:103]
    v_mfma_f32_16x16x32_bf16 v[92:95], v[196:199], a[24:27], v[92:95]
    buffer_load_dwordx4 v[172:175], v47, s[16:19], s45 offen offset:2048 sc1
    v_mfma_f32_16x16x32_bf16 v[96:99], v[200:203], a[24:27], v[96:99]
    ds_write_b128 v28, v[72:75] offset:27648
    v_mfma_f32_16x16x32_bf16 v[88:91], v[200:203], a[8:11], v[88:91]
    v_mfma_f32_16x16x32_bf16 v[84:87], v[196:199], a[8:11], v[84:87]
    s_waitcnt vmcnt(15)
    v_mfma_f32_16x16x32_bf16 v[108:111], v[204:207], a[60:63], v[108:111]
    s_nop 0
    buffer_load_dwordx4 v[176:179], v47, s[16:19], s45 offen offset:3072 sc1
    v_mfma_f32_16x16x32_bf16 v[112:115], v[208:211], a[60:63], v[112:115]
    v_mfma_f32_16x16x32_bf16 v[104:107], v[208:211], a[44:47], v[104:107]
    ds_write_b128 v28, v[60:63] offset:24576
    v_mfma_f32_16x16x32_bf16 v[100:103], v[204:207], a[44:47], v[100:103]
    v_mfma_f32_16x16x32_bf16 v[92:95], v[204:207], a[28:31], v[92:95]
    buffer_load_dwordx4 v[196:199], v47, s[16:19], s46 offen offset:0 sc1
    v_mfma_f32_16x16x32_bf16 v[96:99], v[208:211], a[28:31], v[96:99]
    v_mfma_f32_16x16x32_bf16 v[88:91], v[208:211], a[12:15], v[88:91]
    v_mfma_f32_16x16x32_bf16 v[84:87], v[204:207], a[12:15], v[84:87]
    ds_write_b128 v28, v[64:67] offset:25600
    s_waitcnt vmcnt(15)
    s_nop 0
    v_mfma_f32_16x16x32_bf16 v[108:111], v[116:119], a[112:115], v[108:111]
    buffer_load_dwordx4 v[200:203], v47, s[16:19], s46 offen offset:1024 sc1
    v_mfma_f32_16x16x32_bf16 v[112:115], v[120:123], a[112:115], v[112:115]
    v_mfma_f32_16x16x32_bf16 v[104:107], v[120:123], a[96:99], v[104:107]
    v_mfma_f32_16x16x32_bf16 v[100:103], v[116:119], a[96:99], v[100:103]
    v_mfma_f32_16x16x32_bf16 v[92:95], v[116:119], a[80:83], v[92:95]
    buffer_load_dwordx4 v[204:207], v47, s[16:19], s46 offen offset:2048 sc1
    v_mfma_f32_16x16x32_bf16 v[96:99], v[120:123], a[80:83], v[96:99]
    s_waitcnt lgkmcnt(0)
    s_barrier
    ds_read_b128 v[212:215], v29 offset:24576
    v_mfma_f32_16x16x32_bf16 v[88:91], v[120:123], a[64:67], v[88:91]
    ds_read_b128 v[216:219], v29 offset:25600
    ds_read_b128 v[220:223], v30 offset:26624
    v_mfma_f32_16x16x32_bf16 v[84:87], v[116:119], a[64:67], v[84:87]
    ds_read_b128 v[224:227], v30 offset:27648
    s_waitcnt vmcnt(15)
    s_nop 0
    v_mfma_f32_16x16x32_bf16 v[108:111], v[124:127], a[116:119], v[108:111]
    buffer_load_dwordx4 v[208:211], v47, s[16:19], s46 offen offset:3072 sc1
    v_mfma_f32_16x16x32_bf16 v[112:115], v[128:131], a[116:119], v[112:115]
    ds_read_b128 v[228:231], v31 offset:28672
    ds_read_b128 v[232:235], v31 offset:29696
    v_mfma_f32_16x16x32_bf16 v[104:107], v[128:131], a[100:103], v[104:107]
    v_mfma_f32_16x16x32_bf16 v[100:103], v[124:127], a[100:103], v[100:103]
    v_mfma_f32_16x16x32_bf16 v[92:95], v[124:127], a[84:87], v[92:95]
    buffer_load_dwordx4 v[116:119], v47, s[16:19], s47 offen offset:0 sc1
    v_mfma_f32_16x16x32_bf16 v[96:99], v[128:131], a[84:87], v[96:99]
    v_mfma_f32_16x16x32_bf16 v[88:91], v[128:131], a[68:71], v[88:91]
    s_waitcnt lgkmcnt(5)
    v_add_f32 v52, v52, v212
    v_add_f32 v53, v53, v213
    v_mfma_f32_16x16x32_bf16 v[84:87], v[124:127], a[68:71], v[84:87]
    v_add_f32_e64 v54, v54, v214
    s_waitcnt vmcnt(15)
    v_mfma_f32_16x16x32_bf16 v[108:111], v[132:135], a[120:123], v[108:111]
    buffer_load_dwordx4 v[120:123], v47, s[16:19], s47 offen offset:1024 sc1
    v_mfma_f32_16x16x32_bf16 v[112:115], v[136:139], a[120:123], v[112:115]
    v_add_f32 v55, v55, v215
    s_waitcnt lgkmcnt(4)
    v_add_f32_e64 v56, v56, v216
    v_mfma_f32_16x16x32_bf16 v[104:107], v[136:139], a[104:107], v[104:107]
    v_add_f32 v57, v57, v217
    v_add_f32 v58, v58, v218
    v_mfma_f32_16x16x32_bf16 v[100:103], v[132:135], a[104:107], v[100:103]
    v_add_f32 v59, v59, v219
    s_waitcnt lgkmcnt(3)
    v_add_f32 v52, v52, v220
    v_mfma_f32_16x16x32_bf16 v[92:95], v[132:135], a[88:91], v[92:95]
    buffer_load_dwordx4 v[124:127], v47, s[16:19], s47 offen offset:2048 sc1
    v_mfma_f32_16x16x32_bf16 v[96:99], v[136:139], a[88:91], v[96:99]
    v_add_f32 v53, v53, v221
    v_add_f32 v54, v54, v222
    v_mfma_f32_16x16x32_bf16 v[88:91], v[136:139], a[72:75], v[88:91]
    v_add_f32 v55, v55, v223
    s_waitcnt lgkmcnt(2)
    v_add_f32 v56, v56, v224
    v_mfma_f32_16x16x32_bf16 v[84:87], v[132:135], a[72:75], v[84:87]
    v_add_f32 v57, v57, v225
    s_waitcnt vmcnt(15)
    v_mfma_f32_16x16x32_bf16 v[108:111], v[140:143], a[124:127], v[108:111]
    buffer_load_dwordx4 v[128:131], v47, s[16:19], s47 offen offset:3072 sc1
    v_mfma_f32_16x16x32_bf16 v[112:115], v[144:147], a[124:127], v[112:115]
    s_cmp_eq_u32 s52, 3
    s_cbranch_scc1 L_z1ld
L_z1ldr:
    v_mfma_f32_16x16x32_bf16 v[104:107], v[144:147], a[108:111], v[104:107]
    v_add_f32 v58, v58, v226
    v_add_f32 v59, v59, v227
    v_mfma_f32_16x16x32_bf16 v[100:103], v[140:143], a[108:111], v[100:103]
    s_waitcnt lgkmcnt(1)
    v_add_f32 v52, v52, v228
    v_add_f32_e64 v53, v53, v229
    v_mfma_f32_16x16x32_bf16 v[92:95], v[140:143], a[92:95], v[92:95]
    buffer_load_dwordx4 v[132:135], v46, s[16:19], s40 offen offset:0 sc1
    v_mfma_f32_16x16x32_bf16 v[96:99], v[144:147], a[92:95], v[96:99]
    v_add_f32 v54, v54, v230
    v_add_f32 v55, v55, v231
    v_mfma_f32_16x16x32_bf16 v[88:91], v[144:147], a[76:79], v[88:91]
    s_waitcnt lgkmcnt(0)
    v_add_f32 v56, v56, v232
    v_add_f32 v57, v57, v233
    v_mfma_f32_16x16x32_bf16 v[84:87], v[140:143], a[76:79], v[84:87]
    v_add_f32_e64 v58, v58, v234
    s_waitcnt vmcnt(15)
    v_mfma_f32_16x16x32_bf16 v[108:111], v[148:151], a[176:179], v[108:111]
    buffer_load_dwordx4 v[136:139], v46, s[16:19], s40 offen offset:1024 sc1
    v_mfma_f32_16x16x32_bf16 v[112:115], v[152:155], a[176:179], v[112:115]
    buffer_load_dword v49, v45, s[16:19], 0 offen sc1
    v_mfma_f32_16x16x32_bf16 v[104:107], v[152:155], a[160:163], v[104:107]
    v_add_f32_e64 v59, v59, v235
    v_mfma_f32_16x16x32_bf16 v[100:103], v[148:151], a[160:163], v[100:103]
    v_mfma_f32_16x16x32_bf16 v[92:95], v[148:151], a[144:147], v[92:95]
    buffer_load_dwordx4 v[140:143], v46, s[16:19], s40 offen offset:2048 sc1
    v_mfma_f32_16x16x32_bf16 v[96:99], v[152:155], a[144:147], v[96:99]
    v_mfma_f32_16x16x32_bf16 v[88:91], v[152:155], a[128:131], v[88:91]
    v_mfma_f32_16x16x32_bf16 v[84:87], v[148:151], a[128:131], v[84:87]
    s_waitcnt vmcnt(16)
    s_nop 0
    v_mfma_f32_16x16x32_bf16 v[108:111], v[156:159], a[180:183], v[108:111]
    buffer_load_dwordx4 v[144:147], v46, s[16:19], s40 offen offset:3072 sc1
    v_mfma_f32_16x16x32_bf16 v[112:115], v[160:163], a[180:183], v[112:115]
    v_mfma_f32_16x16x32_bf16 v[104:107], v[160:163], a[164:167], v[104:107]
    v_mfma_f32_16x16x32_bf16 v[100:103], v[156:159], a[164:167], v[100:103]
    v_mfma_f32_16x16x32_bf16 v[92:95], v[156:159], a[148:151], v[92:95]
    buffer_load_dwordx4 v[148:151], v46, s[16:19], s41 offen offset:0 sc1
    v_mfma_f32_16x16x32_bf16 v[96:99], v[160:163], a[148:151], v[96:99]
    v_mfma_f32_16x16x32_bf16 v[88:91], v[160:163], a[132:135], v[88:91]
    v_mfma_f32_16x16x32_bf16 v[84:87], v[156:159], a[132:135], v[84:87]
    s_waitcnt vmcnt(16)
    v_mfma_f32_16x16x32_bf16 v[108:111], v[164:167], a[184:187], v[108:111]
    s_nop 0
    buffer_load_dwordx4 v[152:155], v46, s[16:19], s41 offen offset:1024 sc1
    v_mfma_f32_16x16x32_bf16 v[112:115], v[168:171], a[184:187], v[112:115]
    v_mfma_f32_16x16x32_bf16 v[104:107], v[168:171], a[168:171], v[104:107]
    v_mfma_f32_16x16x32_bf16 v[100:103], v[164:167], a[168:171], v[100:103]
    v_mfma_f32_16x16x32_bf16 v[92:95], v[164:167], a[152:155], v[92:95]
    buffer_load_dwordx4 v[156:159], v46, s[16:19], s41 offen offset:2048 sc1
    v_mfma_f32_16x16x32_bf16 v[96:99], v[168:171], a[152:155], v[96:99]
    v_mfma_f32_16x16x32_bf16 v[88:91], v[168:171], a[136:139], v[88:91]
    v_mfma_f32_16x16x32_bf16 v[84:87], v[164:167], a[136:139], v[84:87]
    s_waitcnt vmcnt(16)
    v_mfma_f32_16x16x32_bf16 v[108:111], v[172:175], a[188:191], v[108:111]
    buffer_load_dwordx4 v[160:163], v46, s[16:19], s41 offen offset:3072 sc1
    s_nop 0
    v_mfma_f32_16x16x32_bf16 v[112:115], v[176:179], a[188:191], v[112:115]
    v_mfma_f32_16x16x32_bf16 v[104:107], v[176:179], a[172:175], v[104:107]
    v_mfma_f32_16x16x32_bf16 v[100:103], v[172:175], a[172:175], v[100:103]
    v_mfma_f32_16x16x32_bf16 v[92:95], v[172:175], a[156:159], v[92:95]
    buffer_load_dwordx4 v[164:167], v46, s[16:19], s42 offen offset:0 sc1
    v_mfma_f32_16x16x32_bf16 v[96:99], v[176:179], a[156:159], v[96:99]
    v_mfma_f32_16x16x32_bf16 v[88:91], v[176:179], a[140:143], v[88:91]
    v_mfma_f32_16x16x32_bf16 v[84:87], v[172:175], a[140:143], v[84:87]
    s_waitcnt vmcnt(16)
    v_mfma_f32_16x16x32_bf16 v[108:111], v[196:199], a[240:243], v[108:111]
    buffer_load_dwordx4 v[168:171], v46, s[16:19], s42 offen offset:1024 sc1
    v_mfma_f32_16x16x32_bf16 v[112:115], v[200:203], a[240:243], v[112:115]
    s_nop 0
    v_mfma_f32_16x16x32_bf16 v[104:107], v[200:203], a[224:227], v[104:107]
    v_mfma_f32_16x16x32_bf16 v[100:103], v[196:199], a[224:227], v[100:103]
    v_mfma_f32_16x16x32_bf16 v[92:95], v[196:199], a[208:211], v[92:95]
    buffer_load_dwordx4 v[172:175], v46, s[16:19], s42 offen offset:2048 sc1
    v_mfma_f32_16x16x32_bf16 v[96:99], v[200:203], a[208:211], v[96:99]
    v_mfma_f32_16x16x32_bf16 v[88:91], v[200:203], a[192:195], v[88:91]
    v_mfma_f32_16x16x32_bf16 v[84:87], v[196:199], a[192:195], v[84:87]
    s_waitcnt vmcnt(16)
    s_nop 0
    v_mfma_f32_16x16x32_bf16 v[108:111], v[204:207], a[244:247], v[108:111]
    buffer_load_dwordx4 v[176:179], v46, s[16:19], s42 offen offset:3072 sc1
    v_mfma_f32_16x16x32_bf16 v[112:115], v[208:211], a[244:247], v[112:115]
    s_cmp_eq_u32 s52, 3
    s_cbranch_scc1 L_unpack
L_unpackr:
    v_mul_f32 v212, v52, v180
    v_mfma_f32_16x16x32_bf16 v[104:107], v[208:211], a[228:231], v[104:107]
    v_mul_f32 v213, v53, v181
    v_mul_f32 v214, v54, v182
    v_mfma_f32_16x16x32_bf16 v[100:103], v[204:207], a[228:231], v[100:103]
    v_mul_f32 v215, v55, v183
    v_mul_f32 v216, v56, v184
    v_mfma_f32_16x16x32_bf16 v[92:95], v[204:207], a[212:215], v[92:95]
    buffer_load_dwordx4 v[196:199], v46, s[16:19], s43 offen offset:0 sc1
    v_mfma_f32_16x16x32_bf16 v[96:99], v[208:211], a[212:215], v[96:99]
    v_mul_f32 v217, v57, v185
    v_mul_f32 v218, v58, v186
    v_mfma_f32_16x16x32_bf16 v[88:91], v[208:211], a[196:199], v[88:91]
    v_mul_f32 v219, v59, v187
    v_cvt_pk_bf16_f32 v236, v212, v213
    v_mfma_f32_16x16x32_bf16 v[84:87], v[204:207], a[196:199], v[84:87]
    v_cvt_pk_bf16_f32 v237, v214, v215
    s_waitcnt vmcnt(16)
    v_mfma_f32_16x16x32_bf16 v[108:111], v[116:119], a[248:251], v[108:111]
    buffer_load_dwordx4 v[200:203], v46, s[16:19], s43 offen offset:1024 sc1
    s_nop 0
    v_mfma_f32_16x16x32_bf16 v[112:115], v[120:123], a[248:251], v[112:115]
    v_cvt_pk_bf16_f32 v238, v216, v217
    v_cvt_pk_bf16_f32 v239, v218, v219
    v_mfma_f32_16x16x32_bf16 v[104:107], v[120:123], a[232:235], v[104:107]
    s_add_u32 s55, s78, 0
    v_min_u32 v239, -2, v239
    v_mfma_f32_16x16x32_bf16 v[100:103], v[116:119], a[232:235], v[100:103]
    buffer_store_dwordx4 v[236:239], v2, s[16:19], s55 offen sc1
    v_mfma_f32_16x16x32_bf16 v[92:95], v[116:119], a[216:219], v[92:95]
    buffer_load_dwordx4 v[204:207], v46, s[16:19], s43 offen offset:2048 sc1
    v_mfma_f32_16x16x32_bf16 v[96:99], v[120:123], a[216:219], v[96:99]
    v_mfma_f32_16x16x32_bf16 v[88:91], v[120:123], a[200:203], v[88:91]
    v_mfma_f32_16x16x32_bf16 v[84:87], v[116:119], a[200:203], v[84:87]
    s_waitcnt vmcnt(17)
    v_mfma_f32_16x16x32_bf16 v[108:111], v[124:127], a[252:255], v[108:111]
    buffer_load_dwordx4 v[208:211], v46, s[16:19], s43 offen offset:3072 sc1
    v_mfma_f32_16x16x32_bf16 v[112:115], v[128:131], a[252:255], v[112:115]
    s_waitcnt vmcnt(15)
    v_cmp_ne_u32 vcc, v49, v43
    s_cbranch_vccnz L_slow5
L_ok5:
    buffer_load_dwordx4 v[244:247], v2, s[16:19], s80 offen sc1
    v_mfma_f32_16x16x32_bf16 v[104:107], v[128:131], a[236:239], v[104:107]
    v_mfma_f32_16x16x32_bf16 v[100:103], v[124:127], a[236:239], v[100:103]
    v_mfma_f32_16x16x32_bf16 v[92:95], v[124:127], a[220:223], v[92:95]
    buffer_load_dwordx4 v[116:119], v46, s[16:19], s44 offen offset:0 sc1
    v_mfma_f32_16x16x32_bf16 v[96:99], v[128:131], a[220:223], v[96:99]
    v_mfma_f32_16x16x32_bf16 v[88:91], v[128:131], a[204:207], v[88:91]
    v_mfma_f32_16x16x32_bf16 v[84:87], v[124:127], a[204:207], v[84:87]
    v_mfma_f32_16x16x32_bf16 v[76:79], v[132:135], a[48:51], 0
    buffer_load_dwordx4 v[120:123], v46, s[16:19], s44 offen offset:1024 sc1
    v_mfma_f32_16x16x32_bf16 v[80:83], v[136:139], a[48:51], 0
    v_mfma_f32_16x16x32_bf16 v[72:75], v[136:139], a[32:35], 0
    v_mfma_f32_16x16x32_bf16 v[68:71], v[132:135], a[32:35], 0
    ds_write_b128 v28, v[108:111] offset:4096
    v_mfma_f32_16x16x32_bf16 v[60:63], v[132:135], a[16:19], 0
    buffer_load_dwordx4 v[124:127], v46, s[16:19], s44 offen offset:2048 sc1
    v_mfma_f32_16x16x32_bf16 v[64:67], v[136:139], a[16:19], 0
    v_mfma_f32_16x16x32_bf16 v[56:59], v[136:139], a[0:3], v[12:15]
    v_mfma_f32_16x16x32_bf16 v[52:55], v[132:135], a[0:3], v[12:15]
    s_waitcnt vmcnt(17)
    v_mfma_f32_16x16x32_bf16 v[76:79], v[140:143], a[52:55], v[76:79]
    buffer_load_dwordx4 v[128:131], v46, s[16:19], s44 offen offset:3072 sc1
    v_mfma_f32_16x16x32_bf16 v[80:83], v[144:147], a[52:55], v[80:83]
    s_nop 0
    ds_write_b128 v28, v[112:115] offset:5120
    v_mfma_f32_16x16x32_bf16 v[72:75], v[144:147], a[36:39], v[72:75]
    v_mfma_f32_16x16x32_bf16 v[68:71], v[140:143], a[36:39], v[68:71]
    v_mfma_f32_16x16x32_bf16 v[60:63], v[140:143], a[20:23], v[60:63]
    buffer_load_dwordx4 v[132:135], v46, s[16:19], s45 offen offset:0 sc1
    v_mfma_f32_16x16x32_bf16 v[64:67], v[144:147], a[20:23], v[64:67]
    v_mfma_f32_16x16x32_bf16 v[56:59], v[144:147], a[4:7], v[56:59]
    ds_write_b128 v28, v[100:103] offset:2048
    v_mfma_f32_16x16x32_bf16 v[52:55], v[140:143], a[4:7], v[52:55]
    s_waitcnt vmcnt(17)
    v_mfma_f32_16x16x32_bf16 v[76:79], v[148:151], a[56:59], v[76:79]
    buffer_load_dwordx4 v[136:139], v46, s[16:19], s45 offen offset:1024 sc1
    s_nop 0
    v_mfma_f32_16x16x32_bf16 v[80:83], v[152:155], a[56:59], v[80:83]
    v_mfma_f32_16x16x32_bf16 v[72:75], v[152:155], a[40:43], v[72:75]
    v_mfma_f32_16x16x32_bf16 v[68:71], v[148:151], a[40:43], v[68:71]
    ds_write_b128 v28, v[104:107] offset:3072
    v_mfma_f32_16x16x32_bf16 v[60:63], v[148:151], a[24:27], v[60:63]
    buffer_load_dwordx4 v[140:143], v46, s[16:19], s45 offen offset:2048 sc1
    v_mfma_f32_16x16x32_bf16 v[64:67], v[152:155], a[24:27], v[64:67]
    v_mfma_f32_16x16x32_bf16 v[56:59], v[152:155], a[8:11], v[56:59]
    v_mfma_f32_16x16x32_bf16 v[52:55], v[148:151], a[8:11], v[52:55]
    s_waitcnt vmcnt(17)
    v_mfma_f32_16x16x32_bf16 v[76:79], v[156:159], a[60:63], v[76:79]
    buffer_load_dwordx4 v[144:147], v46, s[16:19], s45 offen offset:3072 sc1
    s_nop 0
    v_mfma_f32_16x16x32_bf16 v[80:83], v[160:163], a[60:63], v[80:83]
    ds_write_b128 v28, v[92:95] offset:0
    v_mfma_f32_16x16x32_bf16 v[72:75], v[160:163], a[44:47], v[72:75]
    v_mfma_f32_16x16x32_bf16 v[68:71], v[156:159], a[44:47], v[68:71]
    v_mfma_f32_16x16x32_bf16 v[60:63], v[156:159], a[28:31], v[60:63]
    buffer_load_dwordx4 v[148:151], v46, s[16:19], s46 offen offset:0 sc1
    v_mfma_f32_16x16x32_bf16 v[64:67], v[160:163], a[28:31], v[64:67]
    v_mfma_f32_16x16x32_bf16 v[56:59], v[160:163], a[12:15], v[56:59]
    ds_write_b128 v28, v[96:99] offset:1024
    v_mfma_f32_16x16x32_bf16 v[52:55], v[156:159], a[12:15], v[52:55]
    s_waitcnt vmcnt(17)
    v_mfma_f32_16x16x32_bf16 v[76:79], v[164:167], a[112:115], v[76:79]
    s_nop 0
    buffer_load_dwordx4 v[152:155], v46, s[16:19], s46 offen offset:1024 sc1
    v_mfma_f32_16x16x32_bf16 v[80:83], v[168:171], a[112:115], v[80:83]
    v_mfma_f32_16x16x32_bf16 v[72:75], v[168:171], a[96:99], v[72:75]
    v_mfma_f32_16x16x32_bf16 v[68:71], v[164:167], a[96:99], v[68:71]
    s_waitcnt lgkmcnt(0)
    s_barrier
    ds_read_b128 v[212:215], v29 offset:0
    v_mfma_f32_16x16x32_bf16 v[60:63], v[164:167], a[80:83], v[60:63]
    buffer_load_dwordx4 v[156:159], v46, s[16:19], s46 offen offset:2048 sc1
    v_mfma_f32_16x16x32_bf16 v[64:67], v[168:171], a[80:83], v[64:67]
    ds_read_b128 v[216:219], v29 offset:1024
    ds_read_b128 v[220:223], v30 offset:2048
    v_mfma_f32_16x16x32_bf16 v[56:59], v[168:171], a[64:67], v[56:59]
    ds_read_b128 v[224:227], v30 offset:3072
    ds_read_b128 v[228:231], v31 offset:4096
    v_mfma_f32_16x16x32_bf16 v[52:55], v[164:167], a[64:67], v[52:55]
    ds_read_b128 v[232:235], v31 offset:5120
    s_waitcnt vmcnt(17)
    v_mfma_f32_16x16x32_bf16 v[76:79], v[172:175], a[116:119], v[76:79]
    buffer_load_dwordx4 v[160:163], v46, s[16:19], s46 offen offset:3072 sc1
    v_mfma_f32_16x16x32_bf16 v[80:83], v[176:179], a[116:119], v[80:83]
    s_nop 0
    v_mfma_f32_16x16x32_bf16 v[72:75], v[176:179], a[100:103], v[72:75]
    v_mfma_f32_16x16x32_bf16 v[68:71], v[172:175], a[100:103], v[68:71]
    v_mfma_f32_16x16x32_bf16 v[60:63], v[172:175], a[84:87], v[60:63]
    buffer_load_dwordx4 v[164:167], v46, s[16:19], s47 offen offset:0 sc1
    v_mfma_f32_16x16x32_bf16 v[64:67], v[176:179], a[84:87], v[64:67]
    s_waitcnt lgkmcnt(5)
    v_add_f32 v84, v84, v212
    v_add_f32 v85, v85, v213
    v_mfma_f32_16x16x32_bf16 v[56:59], v[176:179], a[68:71], v[56:59]
    v_add_f32 v86, v86, v214
    v_add_f32 v87, v87, v215
    v_mfma_f32_16x16x32_bf16 v[52:55], v[172:175], a[68:71], v[52:55]
    s_waitcnt lgkmcnt(4)
    v_add_f32 v88, v88, v216
    s_waitcnt vmcnt(17)
    v_mfma_f32_16x16x32_bf16 v[76:79], v[196:199], a[120:123], v[76:79]
    buffer_load_dwordx4 v[168:171], v46, s[16:19], s47 offen offset:1024 sc1
    v_mfma_f32_16x16x32_bf16 v[80:83], v[200:203], a[120:123], v[80:83]
    v_add_f32 v89, v89, v217
    v_add_f32 v90, v90, v218
    v_mfma_f32_16x16x32_bf16 v[72:75], v[200:203], a[104:107], v[72:75]
    v_add_f32 v91, v91, v219
    s_waitcnt lgkmcnt(3)
    v_add_f32 v84, v84, v220
    v_mfma_f32_16x16x32_bf16 v[68:71], v[196:199], a[104:107], v[68:71]
    v_add_f32 v85, v85, v221
    v_add_f32_e64 v86, v86, v222
    v_mfma_f32_16x16x32_bf16 v[60:63], v[196:199], a[88:91], v[60:63]
    buffer_load_dwordx4 v[172:175], v46, s[16:19], s47 offen offset:2048 sc1
    v_mfma_f32_16x16x32_bf16 v[64:67], v[200:203], a[88:91], v[64:67]
    v_add_f32 v87, v87, v223
    s_waitcnt lgkmcnt(2)
    v_add_f32 v88, v88, v224
    v_mfma_f32_16x16x32_bf16 v[56:59], v[200:203], a[72:75], v[56:59]
    v_add_f32 v89, v89, v225
    v_add_f32 v90, v90, v226
    v_mfma_f32_16x16x32_bf16 v[52:55], v[196:199], a[72:75], v[52:55]
    v_add_f32 v91, v91, v227
    s_waitcnt vmcnt(16)
    v_mfma_f32_16x16x32_bf16 v[76:79], v[204:207], a[124:127], v[76:79]
    buffer_load_dwordx4 v[176:179], v46, s[16:19], s47 offen offset:3072 sc1
    v_mfma_f32_16x16x32_bf16 v[80:83], v[208:211], a[124:127], v[80:83]
    s_waitcnt lgkmcnt(1)
    v_add_f32 v84, v84, v228
    v_add_f32 v85, v85, v229
    v_mfma_f32_16x16x32_bf16 v[72:75], v[208:211], a[108:111], v[72:75]
    v_add_f32 v86, v86, v230
    v_add_f32 v87, v87, v231
    v_mfma_f32_16x16x32_bf16 v[68:71], v[204:207], a[108:111], v[68:71]
    s_waitcnt lgkmcnt(0)
    v_add_f32 v88, v88, v232
    v_add_f32_e64 v89, v89, v233
    v_mfma_f32_16x16x32_bf16 v[60:63], v[204:207], a[92:95], v[60:63]
    s_add_u32 m0, s1, 0
    s_add_u32 s74, s63, 0
    buffer_load_dwordx4 v2, s[16:19], s74 offen offset:0 sc1 lds
    v_mfma_f32_16x16x32_bf16 v[64:67], v[208:211], a[92:95], v[64:67]
    v_add_f32 v90, v90, v234
    v_add_f32 v91, v91, v235
    v_mfma_f32_16x16x32_bf16 v[56:59], v[208:211], a[76:79], v[56:59]
    s_or_b32 s54, s49, s50
    s_cbranch_scc0 L_epoch
L_epochr:
    v_mul_f32 v212, v84, v188
    v_mfma_f32_16x16x32_bf16 v[52:55], v[204:207], a[76:79], v[52:55]
    v_mul_f32_e64 v213, v85, v189
    s_waitcnt vmcnt(15)
    v_mfma_f32_16x16x32_bf16 v[76:79], v[116:119], a[176:179], v[76:79]
    buffer_load_dwordx4 v2, s[16:19], s74 offen offset:1024 sc1 lds
    v_mfma_f32_16x16x32_bf16 v[80:83], v[120:123], a[176:179], v[80:83]
    v_mul_f32 v214, v86, v190
    v_mul_f32 v215, v87, v191
    v_mfma_f32_16x16x32_bf16 v[72:75], v[120:123], a[160:163], v[72:75]
    v_mul_f32 v216, v88, v192
    v_mul_f32 v217, v89, v193
    v_mfma_f32_16x16x32_bf16 v[68:71], v[116:119], a[160:163], v[68:71]
    v_mul_f32 v218, v90, v194
    v_mul_f32 v219, v91, v195
    v_mfma_f32_16x16x32_bf16 v[60:63], v[116:119], a[144:147], v[60:63]
    buffer_load_dwordx4 v2, s[16:19], s74 offen offset:2048 sc1 lds
    v_mfma_f32_16x16x32_bf16 v[64:67], v[120:123], a[144:147], v[64:67]
    v_cvt_pk_bf16_f32 v240, v212, v213
    v_cvt_pk_bf16_f32 v241, v214, v215
    v_mfma_f32_16x16x32_bf16 v[56:59], v[120:123], a[128:131], v[56:59]
    v_cvt_pk_bf16_f32 v242, v216, v217
    v_cvt_pk_bf16_f32 v243, v218, v219
    v_mfma_f32_16x16x32_bf16 v[52:55], v[116:119], a[128:131], v[52:55]
    s_add_u32 s55, s78, 32768
    s_waitcnt vmcnt(15)
    v_mfma_f32_16x16x32_bf16 v[76:79], v[124:127], a[180:183], v[76:79]
    s_nop 0
    buffer_load_dwordx4 v2, s[16:19], s74 offen offset:3072 sc1 lds
    v_mfma_f32_16x16x32_bf16 v[80:83], v[128:131], a[180:183], v[80:83]
    v_min_u32_e64 v243, -2, v243
    v_mfma_f32_16x16x32_bf16 v[72:75], v[128:131], a[164:167], v[72:75]
    buffer_store_dwordx4 v[240:243], v2, s[16:19], s55 offen sc1
    v_mfma_f32_16x16x32_bf16 v[68:71], v[124:127], a[164:167], v[68:71]
    v_lshlrev_b32_e64 v248, 16, v244
    v_and_b32 v249, 0xffff0000, v244
    v_mfma_f32_16x16x32_bf16 v[60:63], v[124:127], a[148:151], v[60:63]
    s_add_u32 m0, s1, 4096
    s_add_u32 s74, s63, 4096
    buffer_load_dwordx4 v2, s[16:19], s74 offen offset:0 sc1 lds
    v_mfma_f32_16x16x32_bf16 v[64:67], v[128:131], a[148:151], v[64:67]
    v_lshlrev_b32 v250, 16, v245
    v_and_b32 v251, 0xffff0000, v245
    v_mfma_f32_16x16x32_bf16 v[56:59], v[128:131], a[132:135], v[56:59]
    v_lshlrev_b32 v252, 16, v246
    v_and_b32 v253, 0xffff0000, v246
    v_mfma_f32_16x16x32_bf16 v[52:55], v[124:127], a[132:135], v[52:55]
    v_lshlrev_b32 v254, 16, v247
    s_waitcnt vmcnt(16)
    v_mfma_f32_16x16x32_bf16 v[76:79], v[132:135], a[184:187], v[76:79]
    s_add_u32 m0, s1, 5120
    s_add_u32 s74, s65, 0
    buffer_load_dwordx4 v2, s[16:19], s74 offen offset:0 sc1 lds
    v_mfma_f32_16x16x32_bf16 v[80:83], v[136:139], a[184:187], v[80:83]
    s_nop 0
    v_and_b32 v255, 0xffff0000, v247
    v_mfma_f32_16x16x32_bf16 v[72:75], v[136:139], a[168:171], v[72:75]
    v_mfma_f32_16x16x32_bf16 v[68:71], v[132:135], a[168:171], v[68:71]
    v_mfma_f32_16x16x32_bf16 v[60:63], v[132:135], a[152:155], v[60:63]
    buffer_load_dwordx4 v[196:199], v2, s[16:19], s33 offen sc1
    v_mfma_f32_16x16x32_bf16 v[64:67], v[136:139], a[152:155], v[64:67]
    v_mfma_f32_16x16x32_bf16 v[56:59], v[136:139], a[136:139], v[56:59]
    v_mfma_f32_16x16x32_bf16 v[52:55], v[132:135], a[136:139], v[52:55]
    s_waitcnt vmcnt(16)
    v_mfma_f32_16x16x32_bf16 v[76:79], v[140:143], a[188:191], v[76:79]
    buffer_load_dwordx4 v[200:203], v2, s[16:19], s34 offen sc1
    v_mfma_f32_16x16x32_bf16 v[80:83], v[144:147], a[188:191], v[80:83]
    s_nop 0
    v_mfma_f32_16x16x32_bf16 v[72:75], v[144:147], a[172:175], v[72:75]
    v_mfma_f32_16x16x32_bf16 v[68:71], v[140:143], a[172:175], v[68:71]
    v_mfma_f32_16x16x32_bf16 v[60:63], v[140:143], a[156:159], v[60:63]
    buffer_load_dwordx4 v[204:207], v2, s[16:19], s35 offen sc1
    v_mfma_f32_16x16x32_bf16 v[64:67], v[144:147], a[156:159], v[64:67]
    v_mfma_f32_16x16x32_bf16 v[56:59], v[144:147], a[140:143], v[56:59]
    v_mfma_f32_16x16x32_bf16 v[52:55], v[140:143], a[140:143], v[52:55]
    s_waitcnt vmcnt(16)
    s_nop 0
    v_mfma_f32_16x16x32_bf16 v[76:79], v[148:151], a[240:243], v[76:79]
    v_mfma_f32_16x16x32_bf16 v[80:83], v[152:155], a[240:243], v[80:83]
    s_waitcnt vmcnt(14)
    v_mfma_f32_16x16x32_bf16 v[76:79], v[156:159], a[244:247], v[76:79]
    s_nop 0
    v_mfma_f32_16x16x32_bf16 v[80:83], v[160:163], a[244:247], v[80:83]
    buffer_load_dwordx4 v[208:211], v2, s[16:19], s36 offen sc1
    s_waitcnt vmcnt(13)
    v_mfma_f32_16x16x32_bf16 v[76:79], v[164:167], a[248:251], v[76:79]
    s_nop 0
    v_mfma_f32_16x16x32_bf16 v[80:83], v[168:171], a[248:251], v[80:83]
    s_waitcnt vmcnt(11)
    v_mfma_f32_16x16x32_bf16 v[76:79], v[172:175], a[252:255], v[76:79]
    v_mfma_f32_16x16x32_bf16 v[80:83], v[176:179], a[252:255], v[80:83]
    s_nop 0
    buffer_load_dwordx4 v[116:119], v2, s[16:19], s37 offen sc1
    v_mfma_f32_16x16x32_bf16 v[68:71], v[148:151], a[224:227], v[68:71]
    s_nop 1
    v_mfma_f32_16x16x32_bf16 v[72:75], v[152:155], a[224:227], v[72:75]
    s_nop 1
    v_mfma_f32_16x16x32_bf16 v[68:71], v[156:159], a[228:231], v[68:71]
    ds_write_b128 v28, v[76:79] offset:28672
    v_mfma_f32_16x16x32_bf16 v[72:75], v[160:163], a[228:231], v[72:75]
    buffer_load_dwordx4 v[120:123], v2, s[16:19], s38 offen sc1
    v_mfma_f32_16x16x32_bf16 v[68:71], v[164:167], a[232:235], v[68:71]
    v_mfma_f32_16x16x32_bf16 v[72:75], v[168:171], a[232:235], v[72:75]
    ds_write_b128 v28, v[80:83] offset:29696
    v_mfma_f32_16x16x32_bf16 v[68:71], v[172:175], a[236:239], v[68:71]
    v_mfma_f32_16x16x32_bf16 v[72:75], v[176:179], a[236:239], v[72:75]
    buffer_load_dwordx4 v[124:127], v2, s[16:19], s39 offen sc1
    v_mfma_f32_16x16x32_bf16 v[60:63], v[148:151], a[208:211], v[60:63]
    s_nop 1
    s_nop 0
    v_mfma_f32_16x16x32_bf16 v[64:67], v[152:155], a[208:211], v[64:67]
    s_nop 1
    v_mfma_f32_16x16x32_bf16 v[60:63], v[156:159], a[212:215], v[60:63]
    ds_write_b128 v28, v[68:71] offset:26624
    s_nop 0
    v_mfma_f32_16x16x32_bf16 v[64:67], v[160:163], a[212:215], v[64:67]
    buffer_load_dwordx4 v2, s[16:19], s74 offen offset:1024 sc1 lds
    v_mfma_f32_16x16x32_bf16 v[60:63], v[164:167], a[216:219], v[60:63]
    v_mfma_f32_16x16x32_bf16 v[64:67], v[168:171], a[216:219], v[64:67]
    ds_write_b128 v28, v[72:75] offset:27648
    v_mfma_f32_16x16x32_bf16 v[60:63], v[172:175], a[220:223], v[60:63]
    v_mfma_f32_16x16x32_bf16 v[64:67], v[176:179], a[220:223], v[64:67]
    buffer_load_dwordx4 v2, s[16:19], s74 offen offset:2048 sc1 lds
    v_mfma_f32_16x16x32_bf16 v[52:55], v[148:151], a[192:195], v[52:55]
    s_nop 1
    v_mfma_f32_16x16x32_bf16 v[56:59], v[152:155], a[192:195], v[56:59]
    s_nop 1
    v_mfma_f32_16x16x32_bf16 v[52:55], v[156:159], a[196:199], v[52:55]
    ds_write_b128 v28, v[60:63] offset:24576
    v_mfma_f32_16x16x32_bf16 v[56:59], v[160:163], a[196:199], v[56:59]
    buffer_load_dwordx4 v2, s[16:19], s74 offen offset:3072 sc1 lds
    v_mfma_f32_16x16x32_bf16 v[52:55], v[164:167], a[200:203], v[52:55]
    v_mfma_f32_16x16x32_bf16 v[56:59], v[168:171], a[200:203], v[56:59]
    ds_write_b128 v28, v[64:67] offset:25600
    v_mfma_f32_16x16x32_bf16 v[52:55], v[172:175], a[204:207], v[52:55]
    v_mfma_f32_16x16x32_bf16 v[56:59], v[176:179], a[204:207], v[56:59]
    s_add_u32 m0, s1, 9216
    s_add_u32 s74, s65, 4096
    buffer_load_dwordx4 v2, s[16:19], s74 offen offset:0 sc1 lds
    s_add_u32 m0, s1, 40960
    s_add_u32 s74, s63, 5120
    buffer_load_dwordx4 v2, s[16:19], s74 offen offset:0 sc1 lds
    buffer_load_dwordx4 v2, s[16:19], s74 offen offset:1024 sc1 lds
    s_waitcnt lgkmcnt(0)
    s_barrier
    ds_read_b128 v[212:215], v29 offset:24576
    buffer_load_dwordx4 v2, s[16:19], s74 offen offset:2048 sc1 lds
    ds_read_b128 v[216:219], v29 offset:25600
    ds_read_b128 v[220:223], v30 offset:26624
    ds_read_b128 v[224:227], v30 offset:27648
    ds_read_b128 v[228:231], v31 offset:28672
    ds_read_b128 v[232:235], v31 offset:29696
    s_waitcnt lgkmcnt(5)
    s_nop 0
    v_pk_add_f32 v[52:53], v[52:53], v[212:213]
    buffer_load_dwordx4 v2, s[16:19], s74 offen offset:3072 sc1 lds
    v_pk_add_f32 v[54:55], v[54:55], v[214:215]
    s_waitcnt lgkmcnt(4)
    s_nop 0
    v_pk_add_f32 v[56:57], v[56:57], v[216:217]
    v_pk_add_f32 v[58:59], v[58:59], v[218:219]
    s_waitcnt lgkmcnt(3)
    v_pk_add_f32 v[52:53], v[52:53], v[220:221]
    s_nop 0
    v_pk_add_f32 v[54:55], v[54:55], v[222:223]
    s_waitcnt lgkmcnt(2)
    v_pk_add_f32 v[56:57], v[56:57], v[224:225]
    v_pk_add_f32 v[58:59], v[58:59], v[226:227]
    s_nop 0
    s_add_u32 m0, s1, 45056
    s_add_u32 s74, s63, 9216
    buffer_load_dwordx4 v2, s[16:19], s74 offen offset:0 sc1 lds
    s_waitcnt lgkmcnt(1)
    s_nop 0
    v_pk_add_f32 v[52:53], v[52:53], v[228:229]
    v_pk_add_f32 v[54:55], v[54:55], v[230:231]
    s_waitcnt lgkmcnt(0)
    v_pk_add_f32 v[56:57], v[56:57], v[232:233]
    s_nop 0
    v_pk_add_f32 v[58:59], v[58:59], v[234:235]
    v_pk_mul_f32 v[212:213], v[52:53], v[248:249]
    v_pk_mul_f32 v[214:215], v[54:55], v[250:251]
    v_pk_mul_f32 v[216:217], v[56:57], v[252:253]
    v_pk_mul_f32 v[218:219], v[58:59], v[254:255]
    s_add_u32 m0, s1, 46080
    s_add_u32 s74, s65, 5120
    buffer_load_dwordx4 v2, s[16:19], s74 offen offset:0 sc1 lds
    v_cvt_pk_bf16_f32 v244, v212, v213
    v_cvt_pk_bf16_f32 v245, v214, v215
    v_cvt_pk_bf16_f32 v246, v216, v217
    v_cvt_pk_bf16_f32 v247, v218, v219
    s_add_u32 s55, s78, 65536
    v_min_u32 v247, -2, v247
    buffer_store_dwordx4 v[244:247], v2, s[16:19], s55 offen sc1
    s_waitcnt vmcnt(15)
    v_max3_u32 v4, v199, v203, v207
    s_waitcnt vmcnt(13)
    v_max3_u32 v4, v4, v211, v119
    s_waitcnt vmcnt(11)
    v_max3_u32 v4, v4, v123, v127
    v_cmp_eq_u32 vcc, -1, v4
    s_cbranch_vccnz L_slow6
L_ok6:
    s_barrier
    buffer_load_dwordx4 v2, s[16:19], s74 offen offset:1024 sc1 lds
    ds_read_b128 a[0:3], v2 offset:4096
    ds_read_b128 a[4:7], v16 offset:0
    s_nop 0
    ds_read_b128 a[8:11], v17 offset:0
    ds_read_b128 a[12:15], v18 offset:0
    ds_read_b128 a[16:19], v19 offset:0
    ds_read_b128 a[20:23], v2 offset:14336
    ds_read_b128 a[24:27], v16 offset:10240
    ds_read_b128 a[28:31], v17 offset:10240
    buffer_load_dwordx4 v2, s[16:19], s74 offen offset:2048 sc1 lds
    ds_read_b128 a[32:35], v18 offset:10240
    ds_read_b128 a[36:39], v19 offset:10240
    s_waitcnt lgkmcnt(5)
    v_mfma_f32_16x16x32_bf16 v[76:79], a[0:3], v[236:239], 0
    buffer_load_dwordx4 v2, s[16:19], s74 offen offset:3072 sc1 lds
    s_nop 0
    v_mfma_f32_16x16x32_bf16 v[60:63], v[236:239], a[4:7], 0
    ds_read_b128 a[40:43], v2 offset:24576
    ds_read_b128 a[44:47], v16 offset:20480
    v_mfma_f32_16x16x32_bf16 v[64:67], v[236:239], a[8:11], 0
    ds_read_b128 a[48:51], v17 offset:20480
    ds_read_b128 a[52:55], v18 offset:20480
    v_mfma_f32_16x16x32_bf16 v[68:71], v[236:239], a[12:15], 0
    s_add_u32 m0, s1, 50176
    s_add_u32 s74, s65, 9216
    buffer_load_dwordx4 v2, s[16:19], s74 offen offset:0 sc1 lds
    v_mfma_f32_16x16x32_bf16 v[72:75], v[236:239], a[16:19], 0
    ds_read_b128 a[56:59], v19 offset:20480
    ds_read_b128 a[60:63], v2 offset:34816
    s_waitcnt lgkmcnt(6)
    v_mfma_f32_16x16x32_bf16 v[76:79], a[20:23], v[196:199], v[76:79]
    ds_read_b128 a[64:67], v16 offset:30720
    s_nop 0
    ds_read_b128 a[68:71], v17 offset:30720
    buffer_load_dwordx4 v[128:131], v8, s[16:19], s33 offen sc1
    v_mfma_f32_16x16x32_bf16 v[60:63], v[196:199], a[24:27], v[60:63]
    ds_read_b128 a[72:75], v18 offset:30720
    ds_read_b128 a[76:79], v19 offset:30720
    v_mfma_f32_16x16x32_bf16 v[64:67], v[196:199], a[28:31], v[64:67]
    s_waitcnt vmcnt(12)
    s_barrier
    buffer_load_dwordx4 v[132:135], v8, s[16:19], s34 offen sc1
    v_mfma_f32_16x16x32_bf16 v[68:71], v[196:199], a[32:35], v[68:71]
    ds_read_b128 a[80:83], v2 offset:9216
    ds_read_b128 a[84:87], v16 offset:5120
    v_mfma_f32_16x16x32_bf16 v[72:75], v[196:199], a[36:39], v[72:75]
    ds_read_b128 a[88:91], v17 offset:5120
    ds_read_b128 a[92:95], v18 offset:5120
    s_waitcnt lgkmcnt(9)
    v_mfma_f32_16x16x32_bf16 v[76:79], a[40:43], v[200:203], v[76:79]
    s_nop 0
    buffer_load_dwordx4 v[136:139], v8, s[16:19], s35 offen sc1
    v_mfma_f32_16x16x32_bf16 v[60:63], v[200:203], a[44:47], v[60:63]
    ds_read_b128 a[96:99], v19 offset:5120
    ds_read_b128 a[100:103], v2 offset:19456
    v_mfma_f32_16x16x32_bf16 v[64:67], v[200:203], a[48:51], v[64:67]
    ds_read_b128 a[104:107], v16 offset:15360
    ds_read_b128 a[108:111], v17 offset:15360
    v_mfma_f32_16x16x32_bf16 v[68:71], v[200:203], a[52:55], v[68:71]
    buffer_load_dwordx4 v[140:143], v8, s[16:19], s36 offen sc1
    v_mfma_f32_16x16x32_bf16 v[72:75], v[200:203], a[56:59], v[72:75]
    ds_read_b128 a[112:115], v18 offset:15360
    ds_read_b128 a[116:119], v19 offset:15360
    s_waitcnt lgkmcnt(10)
    v_mfma_f32_16x16x32_bf16 v[76:79], a[60:63], v[204:207], v[76:79]
    ds_read_b128 a[120:123], v2 offset:29696
    ds_read_b128 a[124:127], v16 offset:25600
    s_nop 0
    v_mfma_f32_16x16x32_bf16 v[60:63], v[204:207], a[64:67], v[60:63]
    ds_read_b128 a[128:131], v17 offset:25600
    buffer_load_dwordx4 v[144:147], v8, s[16:19], s37 offen sc1
    v_mfma_f32_16x16x32_bf16 v[64:67], v[204:207], a[68:71], v[64:67]
    ds_read_b128 a[132:135], v18 offset:25600
    ds_read_b128 a[136:139], v19 offset:25600
    v_mfma_f32_16x16x32_bf16 v[68:71], v[204:207], a[72:75], v[68:71]
    ds_read_b128 a[140:143], v2 offset:39936
    ds_read_b128 a[144:147], v16 offset:35840
    v_mfma_f32_16x16x32_bf16 v[72:75], v[204:207], a[76:79], v[72:75]
    ds_read_b128 a[148:151], v17 offset:35840
    buffer_load_dwordx4 v[148:151], v8, s[16:19], s38 offen sc1
    s_waitcnt lgkmcnt(13)
    v_mfma_f32_16x16x32_bf16 v[76:79], a[80:83], v[208:211], v[76:79]
    ds_read_b128 a[152:155], v18 offset:35840
    ds_read_b128 a[156:159], v19 offset:35840
    s_nop 0
    v_mfma_f32_16x16x32_bf16 v[60:63], v[208:211], a[84:87], v[60:63]
    s_waitcnt vmcnt(12)
    s_barrier
    buffer_load_dwordx4 v[152:155], v8, s[16:19], s39 offen sc1
    v_mfma_f32_16x16x32_bf16 v[64:67], v[208:211], a[88:91], v[64:67]
    ds_read_b128 a[160:163], v2 offset:45056
    ds_read_b128 a[164:167], v16 offset:40960
    v_mfma_f32_16x16x32_bf16 v[68:71], v[208:211], a[92:95], v[68:71]
    ds_read_b128 a[168:171], v17 offset:40960
    ds_read_b128 a[172:175], v18 offset:40960
    v_mfma_f32_16x16x32_bf16 v[72:75], v[208:211], a[96:99], v[72:75]
    s_add_u32 m0, s1, 81920
    s_add_u32 s74, s64, 0
    s_nop 0
    buffer_load_dwordx4 v2, s[16:19], s74 offen offset:0 sc1 lds
    s_waitcnt lgkmcnt(14)
    v_mfma_f32_16x16x32_bf16 v[76:79], a[100:103], v[116:119], v[76:79]
    ds_read_b128 a[176:179], v19 offset:40960
    s_nop 0
    ds_read_b128 a[180:183], v2 offset:55296
    v_mfma_f32_16x16x32_bf16 v[60:63], v[116:119], a[104:107], v[60:63]
    ds_read_b128 a[184:187], v16 offset:51200
    ds_read_b128 a[188:191], v17 offset:51200
    v_mfma_f32_16x16x32_bf16 v[64:67], v[116:119], a[108:111], v[64:67]
    buffer_load_dwordx4 v2, s[16:19], s74 offen offset:1024 sc1 lds
    v_mfma_f32_16x16x32_bf16 v[68:71], v[116:119], a[112:115], v[68:71]
    ds_read_b128 a[192:195], v18 offset:51200
    ds_read_b128 a[196:199], v19 offset:51200
    v_mfma_f32_16x16x32_bf16 v[72:75], v[116:119], a[116:119], v[72:75]
    ds_read_b128 a[200:203], v51 offset:4096
    ds_read_b128 a[204:207], v20 offset:0
    s_waitcnt lgkmcnt(15)
    v_mfma_f32_16x16x32_bf16 v[76:79], a[120:123], v[120:123], v[76:79]
    buffer_load_dwordx4 v2, s[16:19], s74 offen offset:2048 sc1 lds
    v_mfma_f32_16x16x32_bf16 v[60:63], v[120:123], a[124:127], v[60:63]
    s_nop 0
    ds_read_b128 a[208:211], v21 offset:0
    ds_read_b128 a[212:215], v22 offset:0
    v_mfma_f32_16x16x32_bf16 v[64:67], v[120:123], a[128:131], v[64:67]
    ds_read_b128 a[216:219], v23 offset:0
    ds_read_b128 a[220:223], v51 offset:14336
    v_mfma_f32_16x16x32_bf16 v[68:71], v[120:123], a[132:135], v[68:71]
    buffer_load_dwordx4 v2, s[16:19], s74 offen offset:3072 sc1 lds
    v_mfma_f32_16x16x32_bf16 v[72:75], v[120:123], a[136:139], v[72:75]
    ds_read_b128 a[224:227], v20 offset:10240
    ds_read_b128 a[228:231], v21 offset:10240
    s_waitcnt lgkmcnt(15)
    v_mfma_f32_16x16x32_bf16 v[76:79], a[140:143], v[124:127], v[76:79]
    s_nop 0
    ds_read_b128 a[232:235], v22 offset:10240
    ds_read_b128 a[236:239], v23 offset:10240
    v_mfma_f32_16x16x32_bf16 v[60:63], v[124:127], a[144:147], v[60:63]
    v_mfma_f32_16x16x32_bf16 v[64:67], v[124:127], a[148:151], v[64:67]
    s_add_u32 m0, s1, 86016
    s_add_u32 s74, s64, 4096
    buffer_load_dwordx4 v2, s[16:19], s74 offen offset:0 sc1 lds
    v_mfma_f32_16x16x32_bf16 v[68:71], v[124:127], a[152:155], v[68:71]
    v_mfma_f32_16x16x32_bf16 v[72:75], v[124:127], a[156:159], v[72:75]
    s_waitcnt lgkmcnt(15)
    v_mfma_f32_16x16x32_bf16 v[76:79], a[160:163], v[240:243], v[76:79]
    s_add_u32 m0, s1, 87040
    s_add_u32 s74, s66, 0
    buffer_load_dwordx4 v2, s[16:19], s74 offen offset:0 sc1 lds
    v_mfma_f32_16x16x32_bf16 v[60:63], v[240:243], a[164:167], v[60:63]
    s_waitcnt vmcnt(13)
    s_barrier
    buffer_load_dwordx4 v2, s[16:19], s74 offen offset:1024 sc1 lds
    v_mfma_f32_16x16x32_bf16 v[64:67], v[240:243], a[168:171], v[64:67]
    ds_read_b128 a[0:3], v2 offset:50176
    ds_read_b128 a[4:7], v16 offset:46080
    v_mfma_f32_16x16x32_bf16 v[68:71], v[240:243], a[172:175], v[68:71]
    s_waitcnt vmcnt(13)
    v_cmp_eq_u32 vcc, -1, v131
    s_cbranch_vccnz L_slow7
L_ok7:
    v_mfma_f32_16x16x32_bf16 v[72:75], v[240:243], a[176:179], v[72:75]
    buffer_load_dwordx4 v2, s[16:19], s74 offen offset:2048 sc1 lds
    s_waitcnt lgkmcnt(12)
    v_mfma_f32_16x16x32_bf16 v[76:79], a[180:183], v[128:131], v[76:79]
    ds_read_b128 a[8:11], v17 offset:46080
    ds_read_b128 a[12:15], v18 offset:46080
    v_mfma_f32_16x16x32_bf16 v[60:63], v[128:131], a[184:187], v[60:63]
    ds_read_b128 a[16:19], v19 offset:46080
    ds_read_b128 a[20:23], v2 offset:60416
    v_mfma_f32_16x16x32_bf16 v[64:67], v[128:131], a[188:191], v[64:67]
    buffer_load_dwordx4 v2, s[16:19], s74 offen offset:3072 sc1 lds
    v_mfma_f32_16x16x32_bf16 v[68:71], v[128:131], a[192:195], v[68:71]
    s_waitcnt vmcnt(13)
    v_max_u32 v4, v135, v139
    v_cmp_eq_u32 vcc, -1, v4
    s_cbranch_vccnz L_slow8
L_ok8:
    v_mfma_f32_16x16x32_bf16 v[72:75], v[128:131], a[196:199], v[72:75]
    ds_read_b128 a[24:27], v16 offset:56320
    s_add_u32 m0, s1, 91136
    s_add_u32 s74, s66, 4096
    buffer_load_dwordx4 v2, s[16:19], s74 offen offset:0 sc1 lds
    s_waitcnt lgkmcnt(12)
    v_mfma_f32_16x16x32_bf16 v[76:79], a[200:203], v[132:135], v[76:79]
    ds_read_b128 a[28:31], v17 offset:56320
    ds_read_b128 a[32:35], v18 offset:56320
    s_nop 0
    v_mfma_f32_16x16x32_bf16 v[60:63], v[132:135], a[204:207], v[60:63]
    ds_read_b128 a[36:39], v19 offset:56320
    ds_read_b128 a[40:43], v51 offset:9216
    v_mfma_f32_16x16x32_bf16 v[64:67], v[132:135], a[208:211], v[64:67]
    buffer_load_dwordx4 v[84:87], v9, s[16:19], s33 offen sc1
    v_mfma_f32_16x16x32_bf16 v[68:71], v[132:135], a[212:215], v[68:71]
    ds_read_b128 a[44:47], v20 offset:5120
    ds_read_b128 a[48:51], v21 offset:5120
    v_mfma_f32_16x16x32_bf16 v[72:75], v[132:135], a[216:219], v[72:75]
    ds_read_b128 a[52:55], v22 offset:5120
    ds_read_b128 a[56:59], v23 offset:5120
    s_waitcnt lgkmcnt(15)
    s_nop 0
    v_mfma_f32_16x16x32_bf16 v[76:79], a[220:223], v[136:139], v[76:79]
    buffer_load_dwordx4 v[88:91], v9, s[16:19], s34 offen sc1
    v_mfma_f32_16x16x32_bf16 v[60:63], v[136:139], a[224:227], v[60:63]
    ds_read_b128 a[60:63], v51 offset:19456
    ds_read_b128 a[64:67], v20 offset:15360
    v_mfma_f32_16x16x32_bf16 v[64:67], v[136:139], a[228:231], v[64:67]
    ds_read_b128 a[68:71], v21 offset:15360
    ds_read_b128 a[72:75], v22 offset:15360
    v_mfma_f32_16x16x32_bf16 v[68:71], v[136:139], a[232:235], v[68:71]
    s_waitcnt vmcnt(14)
    v_max_u32 v4, v143, v147
    buffer_load_dwordx4 v[92:95], v9, s[16:19], s35 offen sc1
    v_cmp_eq_u32 vcc, -1, v4
    s_cbranch_vccnz L_slow9
L_ok9:
    v_mfma_f32_16x16x32_bf16 v[72:75], v[136:139], a[236:239], v[72:75]
    ds_read_b128 a[76:79], v23 offset:15360
    s_waitcnt lgkmcnt(15)
    v_mfma_f32_16x16x32_bf16 v[76:79], a[0:3], v[140:143], v[76:79]
    s_nop 0
    v_mfma_f32_16x16x32_bf16 v[60:63], v[140:143], a[4:7], v[60:63]
    buffer_load_dwordx4 v[96:99], v9, s[16:19], s36 offen sc1
    v_mfma_f32_16x16x32_bf16 v[64:67], v[140:143], a[8:11], v[64:67]
    v_mfma_f32_16x16x32_bf16 v[68:71], v[140:143], a[12:15], v[68:71]
    v_mfma_f32_16x16x32_bf16 v[72:75], v[140:143], a[16:19], v[72:75]
    s_waitcnt lgkmcnt(10)
    v_mfma_f32_16x16x32_bf16 v[76:79], a[20:23], v[144:147], v[76:79]
    buffer_load_dwordx4 v[100:103], v9, s[16:19], s37 offen sc1
    s_nop 0
    v_mfma_f32_16x16x32_bf16 v[60:63], v[144:147], a[24:27], v[60:63]
    v_mfma_f32_16x16x32_bf16 v[64:67], v[144:147], a[28:31], v[64:67]
    v_mfma_f32_16x16x32_bf16 v[68:71], v[144:147], a[32:35], v[68:71]
    buffer_load_dwordx4 v[104:107], v9, s[16:19], s38 offen sc1
    s_waitcnt vmcnt(16)
    v_max_u32 v4, v151, v155
    v_cmp_eq_u32 vcc, -1, v4
    s_cbranch_vccnz L_slow10
L_ok10:
    v_mfma_f32_16x16x32_bf16 v[72:75], v[144:147], a[36:39], v[72:75]
    s_waitcnt vmcnt(11)
    s_barrier
    buffer_load_dwordx4 v[108:111], v9, s[16:19], s39 offen sc1
    s_waitcnt lgkmcnt(5)
    v_mfma_f32_16x16x32_bf16 v[76:79], a[40:43], v[148:151], v[76:79]
    ds_read_b128 a[80:83], v51 offset:24576
    s_nop 0
    ds_read_b128 a[84:87], v20 offset:20480
    v_mfma_f32_16x16x32_bf16 v[60:63], v[148:151], a[44:47], v[60:63]
    ds_read_b128 a[88:91], v21 offset:20480
    ds_read_b128 a[92:95], v22 offset:20480
    v_mfma_f32_16x16x32_bf16 v[64:67], v[148:151], a[48:51], v[64:67]
    ds_read_b128 a[96:99], v23 offset:20480
    ds_read_b128 a[100:103], v51 offset:34816
    v_mfma_f32_16x16x32_bf16 v[68:71], v[148:151], a[52:55], v[68:71]
    ds_read_b128 a[104:107], v20 offset:30720
    v_mfma_f32_16x16x32_bf16 v[72:75], v[148:151], a[56:59], v[72:75]
    ds_read_b128 a[108:111], v21 offset:30720
    s_waitcnt lgkmcnt(8)
    s_nop 0
    v_mfma_f32_16x16x32_bf16 v[76:79], a[60:63], v[152:155], v[76:79]
    ds_read_b128 a[112:115], v22 offset:30720
    v_mfma_f32_16x16x32_bf16 v[60:63], v[152:155], a[64:67], v[60:63]
    ds_read_b128 a[116:119], v23 offset:30720
    v_mfma_f32_16x16x32_bf16 v[64:67], v[152:155], a[68:71], v[64:67]
    ds_read_b128 a[120:123], v51 offset:45056
    v_mfma_f32_16x16x32_bf16 v[68:71], v[152:155], a[72:75], v[68:71]
    ds_read_b128 a[124:127], v20 offset:40960
    v_mfma_f32_16x16x32_bf16 v[72:75], v[152:155], a[76:79], v[72:75]
    ds_read_b128 a[128:131], v21 offset:40960
    s_waitcnt lgkmcnt(8)
    v_mfma_f32_16x16x32_bf16 v[76:79], a[80:83], v[244:247], v[76:79]
    s_nop 0
    ds_read_b128 a[132:135], v22 offset:40960
    v_mfma_f32_16x16x32_bf16 v[60:63], v[244:247], a[84:87], v[60:63]
    ds_read_b128 a[136:139], v23 offset:40960
    v_mfma_f32_16x16x32_bf16 v[64:67], v[244:247], a[88:91], v[64:67]
    ds_read_b128 a[140:143], v51 offset:55296
    v_mfma_f32_16x16x32_bf16 v[68:71], v[244:247], a[92:95], v[68:71]
    ds_read_b128 a[144:147], v20 offset:51200
    ds_read_b128 a[148:151], v21 offset:51200
    ds_read_b128 a[152:155], v22 offset:51200
    ds_read_b128 a[156:159], v23 offset:51200
    s_waitcnt vmcnt(7)
    s_barrier
    ds_read_b128 a[160:163], v51 offset:29696
    ds_read_b128 a[164:167], v20 offset:25600
    s_waitcnt vmcnt(6)
    v_cmp_eq_u32 vcc, -1, v87
    s_cbranch_vccnz L_slow11
L_ok11:
    v_mfma_f32_16x16x32_bf16 v[72:75], v[244:247], a[96:99], v[72:75]
    s_nop 0
    ds_read_b128 a[168:171], v21 offset:25600
    ds_read_b128 a[172:175], v22 offset:25600
    s_waitcnt lgkmcnt(14)
    v_mfma_f32_16x16x32_bf16 v[76:79], a[100:103], v[84:87], v[76:79]
    s_nop 0
    ds_read_b128 a[176:179], v23 offset:25600
    ds_read_b128 a[180:183], v51 offset:39936
    v_mfma_f32_16x16x32_bf16 v[60:63], v[84:87], a[104:107], v[60:63]
    ds_read_b128 a[184:187], v20 offset:35840
    v_mfma_f32_16x16x32_bf16 v[64:67], v[84:87], a[108:111], v[64:67]
    ds_read_b128 a[188:191], v21 offset:35840
    v_mfma_f32_16x16x32_bf16 v[68:71], v[84:87], a[112:115], v[68:71]
    ds_read_b128 a[192:195], v22 offset:35840
    ds_read_b128 a[196:199], v23 offset:35840
    ds_read_b128 a[200:203], v51 offset:50176
    s_waitcnt vmcnt(4)
    v_max_u32 v4, v91, v95
    v_cmp_eq_u32 vcc, -1, v4
    s_cbranch_vccnz L_slow12
L_ok12:
    v_mfma_f32_16x16x32_bf16 v[72:75], v[84:87], a[116:119], v[72:75]
    ds_read_b128 a[204:207], v20 offset:46080
    ds_read_b128 a[208:211], v21 offset:46080
    s_waitcnt lgkmcnt(15)
    s_nop 0
    v_mfma_f32_16x16x32_bf16 v[76:79], a[120:123], v[88:91], v[76:79]
    ds_read_b128 a[212:215], v22 offset:46080
    v_mfma_f32_16x16x32_bf16 v[60:63], v[88:91], a[124:127], v[60:63]
    ds_read_b128 a[216:219], v23 offset:46080
    v_mfma_f32_16x16x32_bf16 v[64:67], v[88:91], a[128:131], v[64:67]
    ds_read_b128 a[220:223], v51 offset:60416
    v_mfma_f32_16x16x32_bf16 v[68:71], v[88:91], a[132:135], v[68:71]
    ds_read_b128 a[224:227], v20 offset:56320
    v_mfma_f32_16x16x32_bf16 v[72:75], v[88:91], a[136:139], v[72:75]
    ds_read_b128 a[228:231], v21 offset:56320
    s_waitcnt lgkmcnt(15)
    v_mfma_f32_16x16x32_bf16 v[76:79], a[140:143], v[92:95], v[76:79]
    s_nop 0
    ds_read_b128 a[232:235], v22 offset:56320
    v_mfma_f32_16x16x32_bf16 v[60:63], v[92:95], a[144:147], v[60:63]
    ds_read_b128 a[236:239], v23 offset:56320
    v_mfma_f32_16x16x32_bf16 v[64:67], v[92:95], a[148:151], v[64:67]
    v_mfma_f32_16x16x32_bf16 v[68:71], v[92:95], a[152:155], v[68:71]
    s_waitcnt vmcnt(3)
    v_cmp_eq_u32 vcc, -1, v99
    s_cbranch_vccnz L_slow13
L_ok13:
    v_mfma_f32_16x16x32_bf16 v[72:75], v[92:95], a[156:159], v[72:75]
    s_waitcnt lgkmcnt(15)
    v_mfma_f32_16x16x32_bf16 v[76:79], a[160:163], v[96:99], v[76:79]
    v_mfma_f32_16x16x32_bf16 v[60:63], v[96:99], a[164:167], v[60:63]
    v_mfma_f32_16x16x32_bf16 v[64:67], v[96:99], a[168:171], v[64:67]
    v_mfma_f32_16x16x32_bf16 v[68:71], v[96:99], a[172:175], v[68:71]
    s_waitcnt vmcnt(2)
    v_cmp_eq_u32 vcc, -1, v103
    s_cbranch_vccnz L_slow14
L_ok14:
    v_mfma_f32_16x16x32_bf16 v[72:75], v[96:99], a[176:179], v[72:75]
    s_waitcnt lgkmcnt(10)
    v_mfma_f32_16x16x32_bf16 v[76:79], a[180:183], v[100:103], v[76:79]
    v_mfma_f32_16x16x32_bf16 v[60:63], v[100:103], a[184:187], v[60:63]
    v_mfma_f32_16x16x32_bf16 v[64:67], v[100:103], a[188:191], v[64:67]
    v_mfma_f32_16x16x32_bf16 v[68:71], v[100:103], a[192:195], v[68:71]
    s_waitcnt vmcnt(1)
    v_cmp_eq_u32 vcc, -1, v107
    s_cbranch_vccnz L_slow15
L_ok15:
    v_mfma_f32_16x16x32_bf16 v[72:75], v[100:103], a[196:199], v[72:75]
    s_waitcnt lgkmcnt(5)
    v_mfma_f32_16x16x32_bf16 v[76:79], a[200:203], v[104:107], v[76:79]
    v_mfma_f32_16x16x32_bf16 v[60:63], v[104:107], a[204:207], v[60:63]
    v_mfma_f32_16x16x32_bf16 v[64:67], v[104:107], a[208:211], v[64:67]
    v_mfma_f32_16x16x32_bf16 v[68:71], v[104:107], a[212:215], v[68:71]
    s_waitcnt vmcnt(0)
    v_cmp_eq_u32 vcc, -1, v111
    s_cbranch_vccnz L_slow16
L_ok16:
    s_nop 0
    v_mfma_f32_16x16x32_bf16 v[72:75], v[104:107], a[216:219], v[72:75]
    s_waitcnt lgkmcnt(0)
    v_mfma_f32_16x16x32_bf16 v[76:79], a[220:223], v[108:111], v[76:79]
    v_mfma_f32_16x16x32_bf16 v[60:63], v[108:111], a[224:227], v[60:63]
    s_nop 0
    v_mfma_f32_16x16x32_bf16 v[64:67], v[108:111], a[228:231], v[64:67]
    v_mfma_f32_16x16x32_bf16 v[68:71], v[108:111], a[232:235], v[68:71]
    v_mfma_f32_16x16x32_bf16 v[72:75], v[108:111], a[236:239], v[72:75]
    s_nop 3
    s_nop 0
    v_cvt_pk_bf16_f32 v160, v76, v77
    v_cvt_pk_bf16_f32 v161, v78, v79
    ds_bpermute_b32 v162, v41, v160
    ds_bpermute_b32 v163, v41, v161
    v_cvt_pk_bf16_f32 v150, v61, v65
    v_cvt_pk_bf16_f32 v151, v69, v73
    v_cvt_pk_bf16_f32 v148, v60, v64
    v_cvt_pk_bf16_f32 v149, v68, v72
    v_cvt_pk_bf16_f32 v156, v60, v64
    v_cvt_pk_bf16_f32 v157, v68, v72
    v_mov_b32_dpp v148, v150 row_ror:8 row_mask:0xf bank_mask:0xc
    v_mov_b32_dpp v149, v151 row_ror:8 row_mask:0xf bank_mask:0xc
    v_mov_b32_dpp v150, v156 row_ror:8 row_mask:0xf bank_mask:0x3
    v_mov_b32_dpp v151, v157 row_ror:8 row_mask:0xf bank_mask:0x3
    buffer_store_dwordx4 v[148:151], v38, s[20:23], 0 offen offset:0
    v_cvt_pk_bf16_f32 v154, v63, v67
    v_cvt_pk_bf16_f32 v155, v71, v75
    v_cvt_pk_bf16_f32 v152, v62, v66
    v_cvt_pk_bf16_f32 v153, v70, v74
    v_cvt_pk_bf16_f32 v158, v62, v66
    v_cvt_pk_bf16_f32 v159, v70, v74
    v_mov_b32_dpp v152, v154 row_ror:8 row_mask:0xf bank_mask:0xc
    v_mov_b32_dpp v153, v155 row_ror:8 row_mask:0xf bank_mask:0xc
    v_mov_b32_dpp v154, v158 row_ror:8 row_mask:0xf bank_mask:0x3
    v_mov_b32_dpp v155, v159 row_ror:8 row_mask:0xf bank_mask:0x3
    buffer_store_dwordx4 v[152:155], v38, s[20:23], 0 offen offset:2560
    s_waitcnt lgkmcnt(0)
    buffer_store_dwordx2 v[162:163], v39, s[20:23], 0 offen offset:512
    s_endpgm
L_free2:
    buffer_load_dword v55, v12, s[4:7], s61 offen
    s_mov_b32 s18, 16777216
    s_mov_b32 s19, 0x20000
    s_mov_b32 s26, 983040
    s_mov_b32 s27, 0x20000
    s_mov_b32 s30, 4096
    s_mov_b32 s31, 0x20000
    s_mov_b32 s14, 8388608
    s_mov_b32 s15, 0x20000
    s_mov_b32 s22, 2621440
    s_mov_b32 s23, 0x20000
    v_and_b32 v4, 15, v1
    v_lshrrev_b32 v5, 4, v1
    v_xor_b32 v6, v4, v5
    v_lshlrev_b32 v6, 4, v6
    v_lshl_add_u32 v6, v4, 8, v6
    v_add_u32 v8, s72, v6
    v_xor_b32 v9, 64, v8
    v_xor_b32 v10, 128, v8
    v_xor_b32 v11, 192, v8
    v_lshrrev_b32 v4, 4, v1
    v_mul_u32_u24 v4, 4096, v4
    v_and_b32 v5, 0x30, v1
    v_and_b32 v6, 0xf0, v2
    v_xor_b32 v5, v5, v6
    v_add_u32 v16, v4, v5
    v_xor_b32_e64 v4, 64, v16
    v_add_u32 v17, 15360, v4
    v_xor_b32 v4, 128, v16
    v_add_u32 v18, 30720, v4
    v_xor_b32 v4, 192, v16
    v_add_u32 v19, 46080, v4
    s_lshl_b32 s54, s48, 15
    s_nop 0
    s_add_u32 s47, s54, 2097152
    s_lshl_b32 s54, s49, 18
    s_lshl_b32 s55, s48, 10
    s_add_u32 s35, s54, s55
    s_lshl_b32 s55, s50, 2
    s_lshr_b32 s53, 572653568, s55
    buffer_load_dword v60, v20, s[8:11], s66 offen offset:1536
    s_add_u32 s54, s53, 0
    s_and_b32 s54, s54, 3
    s_lshl_b32 s55, s54, 8
    s_lshl_b32 s54, s54, 13
    s_add_u32 s32, s35, s55
    s_add_u32 s40, s47, s54
    s_add_u32 s41, s40, 4096
    s_xor_b32 s54, s48, 0
    s_lshl_b32 s36, s54, 16
    s_mul_i32 s54, s54, 6144
    s_add_u32 s54, s54, 98304
    v_add_u32_e64 v28, s54, v2
    s_add_u32 s54, s53, 1
    s_and_b32 s54, s54, 3
    s_lshl_b32 s55, s54, 8
    s_lshl_b32 s54, s54, 13
    s_add_u32 s33, s35, s55
    s_add_u32 s42, s47, s54
    s_add_u32 s43, s42, 4096
    s_xor_b32 s54, s48, 1
    s_lshl_b32 s37, s54, 16
    s_mul_i32 s54, s54, 6144
    s_add_u32 s54, s54, 98304
    v_add_u32_e64 v29, s54, v2
    s_add_u32 s54, s53, 2
    s_and_b32 s54, s54, 3
    s_lshl_b32 s55, s54, 8
    s_lshl_b32 s54, s54, 13
    s_add_u32 s34, s35, s55
    s_add_u32 s44, s47, s54
    s_add_u32 s45, s44, 4096
    s_xor_b32 s54, s48, 2
    s_lshl_b32 s38, s54, 16
    s_mul_i32 s54, s54, 6144
    s_add_u32 s54, s54, 98304
    v_add_u32_e64 v30, s54, v2
    s_add_u32 s54, s53, 3
    s_and_b32 s54, s54, 3
    s_lshl_b32 s55, s54, 8
    s_lshl_b32 s54, s54, 13
    s_add_u32 s35, s35, s55
    s_add_u32 s46, s47, s54
    s_add_u32 s47, s46, 4096
    s_xor_b32 s54, s48, 3
    s_lshl_b32 s39, s54, 16
    s_mul_i32 s54, s54, 6144
    s_add_u32 s54, s54, 98304
    v_add_u32_e64 v31, s54, v2
    buffer_load_dword v56, v12, s[4:7], s62 offen
    s_mul_i32 s54, s49, 98304
    s_lshl_b32 s55, s48, 13
    s_add_u32 s54, s54, s55
    s_add_u32 s77, s54, 5242880
    s_lshl_b32 s55, s50, 10
    s_add_u32 s78, s77, s55
    v_mov_b32 v4, 0
    buffer_load_dword v43, v4, s[16:19], 0 offen offset:0 sc1
    s_lshl2_add_u32 s54, s49, s48
    s_lshl_b32 s54, s54, 5
    v_and_b32 v4, 15, v1
    v_lshlrev_b32 v4, 1, v4
    buffer_load_ushort v40, v4, s[28:31], s54 offen
    s_mul_i32 s1, s48, 10240
    s_lshl3_add_u32 s54, s49, s50
    s_lshl_b32 s54, s54, 7
    s_add_u32 s81, s54, 65536
    s_mov_b32 s68, 0xbdd2d3e8
    s_mov_b32 s69, 0xbdd2d3e8
    s_nop 0
    v_mov_b32 v36, 0xc0135761
    v_mov_b32 v37, 0xc0135761
    s_and_b32 s80, s49, 1
    s_and_b32 s54, s50, 3
    s_lshl2_add_u32 s79, s80, s54
    s_lshl_b32 s79, s79, 2
    s_lshr_b32 s79, 0x4a86a420, s79
    s_and_b32 s79, s79, 15
    s_mul_i32 s80, s80, -6
    s_add_u32 s80, s80, s54
    s_lshr_b32 s54, s50, 2
    s_mul_i32 s54, s54, 12
    s_add_u32 s79, s79, s54
    s_add_u32 s80, s80, s54
    s_add_u32 s80, s80, 6
    v_lshl_add_u32 v3, s79, 17, v2
    v_add_u32 v47, 131072, v3
    v_lshl_add_u32 v46, s80, 17, v2
    s_lshr_b32 s54, s79, 1
    s_lshr_b32 s55, s80, 1
    s_sub_u32 s54, s54, s55
    v_bfe_u32 v4, v1, 2, 1
    v_mul_lo_u32 v4, s54, v4
    v_add_u32 v4, s55, v4
    v_and_b32 v5, 3, v1
    v_lshl_add_u32 v5, s48, 2, v5
    v_lshl_add_u32 v5, v4, 4, v5
    v_lshlrev_b32 v5, 7, v5
    v_add_u32 v48, 1572864, v5
    v_mov_b32 v44, v4
    s_lshl2_add_u32 s54, s49, s48
    s_mul_i32 s54, s54, 24
    s_add_u32 s79, s79, s54
    s_lshl_b32 s79, s79, 10
    s_add_u32 s79, s79, 8388608
    s_add_u32 s80, s80, s54
    s_lshl_b32 s80, s80, 10
    s_add_u32 s80, s80, 8388608
    v_mul_u32_u24 v4, 86, v44
    v_lshrrev_b32 v4, 8, v4
    v_mul_u32_u24 v5, 3, v4
    v_sub_u32 v5, v44, v5
    v_lshrrev_b32 v6, 1, v4
    v_lshl_add_u32 v5, v6, 2, v5
    v_and_b32 v4, 1, v4
    s_and_b32 s54, s49, 30
    v_add_u32 v4, s54, v4
    v_lshl_add_u32 v4, v4, 3, v5
    v_lshlrev_b32 v4, 7, v4
    v_add_u32 v44, 65536, v4
    s_or_b32 s54, s50, 3
    s_add_u32 s54, s54, 1
    s_cmp_lt_u32 s48, 2
    s_cselect_b32 s54, s50, s54
    s_lshr_b32 s55, s50, 2
    s_add_u32 s54, s54, s55
    s_and_b32 s55, s48, 1
    s_lshl1_add_u32 s54, s54, s55
    s_mul_i32 s54, s54, 3
    v_and_b32 v4, 3, v1
    v_min_u32 v4, 2, v4
    v_add_u32 v4, s54, v4
    v_and_b32 v5, 15, v1
    v_lshl_add_u32 v5, s48, 4, v5
    s_or_b32 s54, s49, s50
    s_cmp_eq_u32 s54, 0
    s_cselect_b64 vcc, -1, 0
    v_cndmask_b32 v4, v4, v5, vcc
    v_lshl_add_u32 v45, v4, 2, 3
    buffer_load_dword v61, v20, s[8:11], s67 offen offset:1536
    buffer_load_dword v62, v20, s[8:11], s63 offen
    buffer_load_dword v63, v20, s[8:11], s64 offen
    s_lshl2_add_u32 s54, s49, s48
    v_cmp_gt_u32 vcc, 32, v1
    v_and_b32 v4, 1, v1
    v_lshl_add_u32 v4, s54, 1, v4
    v_cndmask_b32 v4, v45, v4, vcc
    v_lshlrev_b32 v4, 7, v4
    v_add_u32 v45, 65536, v4
    v_cmp_gt_u32 vcc, 16, v1
    s_nop 1
    v_cndmask_b32 v45, v45, v44, vcc
    v_mov_b32 v4, 1073741824
    v_cmp_eq_u32 vcc, 0, v0
    s_nop 1
    v_cndmask_b32 v0, v4, v0, vcc
    s_add_u32 m0, s72, 0
    s_add_u32 s74, s32, s36
    buffer_load_dwordx4 v16, s[12:15], s74 offen offset:0 lds
    buffer_load_dwordx4 v17, s[12:15], s74 offen offset:1024 lds
    buffer_load_dwordx4 v18, s[12:15], s74 offen offset:2048 lds
    s_waitcnt vmcnt(7)
    s_nop 0
    v_add_u32 v43, 0x7b4a3d25, v43
    s_waitcnt vmcnt(6)
    v_lshlrev_b32 v40, 16, v40
    buffer_load_dwordx4 v19, s[12:15], s74 offen offset:3072 lds
    s_add_u32 m0, s72, 4096
    s_add_u32 s74, s32, s37
    buffer_load_dwordx4 v16, s[12:15], s74 offen offset:0 lds
    buffer_load_dwordx4 v17, s[12:15], s74 offen offset:1024 lds
    buffer_load_dwordx4 v18, s[12:15], s74 offen offset:2048 lds
    s_nop 0
    buffer_load_dwordx4 v19, s[12:15], s74 offen offset:3072 lds
    s_add_u32 m0, s72, 8192
    s_add_u32 s74, s32, s38
    buffer_load_dwordx4 v16, s[12:15], s74 offen offset:0 lds
    s_nop 0
    buffer_load_dwordx4 v17, s[12:15], s74 offen offset:1024 lds
    buffer_load_dwordx4 v18, s[12:15], s74 offen offset:2048 lds
    buffer_load_dwordx4 v19, s[12:15], s74 offen offset:3072 lds
    s_add_u32 m0, s72, 12288
    s_add_u32 s74, s32, s39
    buffer_load_dwordx4 v16, s[12:15], s74 offen offset:0 lds
    buffer_load_dwordx4 v17, s[12:15], s74 offen offset:1024 lds
    buffer_load_dwordx4 v18, s[12:15], s74 offen offset:2048 lds
    s_nop 0
    buffer_load_dwordx4 v19, s[12:15], s74 offen offset:3072 lds
    s_add_u32 m0, s72, 16384
    s_add_u32 s74, s33, s36
    buffer_load_dwordx4 v16, s[12:15], s74 offen offset:0 lds
    s_nop 0
    buffer_load_dwordx4 v17, s[12:15], s74 offen offset:1024 lds
    buffer_load_dwordx4 v18, s[12:15], s74 offen offset:2048 lds
    s_waitcnt vmcnt(15)
    ds_read_b128 a[0:3], v8 offset:0
    s_nop 0
    ds_read_b128 a[4:7], v9 offset:0
    ds_read_b128 a[8:11], v10 offset:0
    ds_read_b128 a[12:15], v11 offset:0
    buffer_load_dwordx4 v19, s[12:15], s74 offen offset:3072 lds
    s_add_u32 m0, s72, 20480
    s_add_u32 s74, s33, s37
    buffer_load_dwordx4 v16, s[12:15], s74 offen offset:0 lds
    buffer_load_dwordx4 v17, s[12:15], s74 offen offset:1024 lds
    s_nop 0
    buffer_load_dwordx4 v18, s[12:15], s74 offen offset:2048 lds
    s_waitcnt vmcnt(15)
    ds_read_b128 a[16:19], v8 offset:4096
    ds_read_b128 a[20:23], v9 offset:4096
    s_nop 0
    ds_read_b128 a[24:27], v10 offset:4096
    ds_read_b128 a[28:31], v11 offset:4096
    buffer_load_dwordx4 v19, s[12:15], s74 offen offset:3072 lds
    s_waitcnt lgkmcnt(4)
    s_add_u32 m0, s72, 0
    s_add_u32 s74, s33, s38
    buffer_load_dwordx4 v16, s[12:15], s74 offen offset:0 lds
    buffer_load_dwordx4 v17, s[12:15], s74 offen offset:1024 lds
    buffer_load_dwordx4 v18, s[12:15], s74 offen offset:2048 lds
    s_waitcnt vmcnt(15)
    ds_read_b128 a[32:35], v8 offset:8192
    ds_read_b128 a[36:39], v9 offset:8192
    ds_read_b128 a[40:43], v10 offset:8192
    ds_read_b128 a[44:47], v11 offset:8192
    buffer_load_dwordx4 v19, s[12:15], s74 offen offset:3072 lds
    s_waitcnt lgkmcnt(4)
    s_add_u32 m0, s72, 4096
    s_add_u32 s74, s33, s39
    buffer_load_dwordx4 v16, s[12:15], s74 offen offset:0 lds
    buffer_load_dwordx4 v17, s[12:15], s74 offen offset:1024 lds
    buffer_load_dwordx4 v18, s[12:15], s74 offen offset:2048 lds
    s_waitcnt vmcnt(15)
    ds_read_b128 a[48:51], v8 offset:12288
    s_nop 0
    ds_read_b128 a[52:55], v9 offset:12288
    ds_read_b128 a[56:59], v10 offset:12288
    ds_read_b128 a[60:63], v11 offset:12288
    buffer_load_dwordx4 v19, s[12:15], s74 offen offset:3072 lds
    s_waitcnt lgkmcnt(4)
    s_add_u32 m0, s72, 8192
    s_add_u32 s74, s34, s36
    buffer_load_dwordx4 v16, s[12:15], s74 offen offset:0 lds
    buffer_load_dwordx4 v17, s[12:15], s74 offen offset:1024 lds
    buffer_load_dwordx4 v18, s[12:15], s74 offen offset:2048 lds
    s_waitcnt vmcnt(15)
    ds_read_b128 a[64:67], v8 offset:16384
    ds_read_b128 a[68:71], v9 offset:16384
    s_nop 0
    ds_read_b128 a[72:75], v10 offset:16384
    ds_read_b128 a[76:79], v11 offset:16384
    buffer_load_dwordx4 v19, s[12:15], s74 offen offset:3072 lds
    s_waitcnt lgkmcnt(4)
    s_nop 0
    s_add_u32 m0, s72, 12288
    s_add_u32 s74, s34, s37
    buffer_load_dwordx4 v16, s[12:15], s74 offen offset:0 lds
    buffer_load_dwordx4 v17, s[12:15], s74 offen offset:1024 lds
    s_nop 0
    buffer_load_dwordx4 v18, s[12:15], s74 offen offset:2048 lds
    s_waitcnt vmcnt(15)
    ds_read_b128 a[80:83], v8 offset:20480
    ds_read_b128 a[84:87], v9 offset:20480
    s_nop 0
    ds_read_b128 a[88:91], v10 offset:20480
    ds_read_b128 a[92:95], v11 offset:20480
    buffer_load_dwordx4 v19, s[12:15], s74 offen offset:3072 lds
    s_waitcnt lgkmcnt(4)
    s_nop 0
    s_add_u32 m0, s72, 16384
    s_add_u32 s74, s34, s38
    buffer_load_dwordx4 v16, s[12:15], s74 offen offset:0 lds
    buffer_load_dwordx4 v17, s[12:15], s74 offen offset:1024 lds
    s_nop 0
    buffer_load_dwordx4 v18, s[12:15], s74 offen offset:2048 lds
    s_waitcnt vmcnt(15)
    ds_read_b128 a[96:99], v8 offset:0
    ds_read_b128 a[100:103], v9 offset:0
    s_nop 0
    ds_read_b128 a[104:107], v10 offset:0
    ds_read_b128 a[108:111], v11 offset:0
    buffer_load_dwordx4 v19, s[12:15], s74 offen offset:3072 lds
    s_waitcnt lgkmcnt(4)
    s_nop 0
    s_add_u32 m0, s72, 20480
    s_add_u32 s74, s34, s39
    buffer_load_dwordx4 v16, s[12:15], s74 offen offset:0 lds
    buffer_load_dwordx4 v17, s[12:15], s74 offen offset:1024 lds
    s_nop 0
    buffer_load_dwordx4 v18, s[12:15], s74 offen offset:2048 lds
    s_waitcnt vmcnt(15)
    ds_read_b128 a[112:115], v8 offset:4096
    ds_read_b128 a[116:119], v9 offset:4096
    s_nop 0
    ds_read_b128 a[120:123], v10 offset:4096
    ds_read_b128 a[124:127], v11 offset:4096
    buffer_load_dwordx4 v19, s[12:15], s74 offen offset:3072 lds
    s_lshl2_add_u32 s54, s52, s48
    s_nop 0
    s_cmp_ge_u32 s54, 240
    s_cselect_b32 s55, 16, 0
    s_sub_u32 s54, s54, s55
    s_mul_i32 s55, s54, 2731
    s_lshr_b32 s76, s55, 16
    s_mul_i32 s55, s76, 24
    s_sub_u32 s75, s54, s55
    s_mul_i32 s54, s75, 40960
    s_lshl_b32 s55, s76, 7
    s_add_u32 s74, s54, s55
    v_lshrrev_b32 v4, 3, v1
    v_mul_u32_u24 v4, 1152, v4
    v_add_u32_e64 v4, v4, v2
    s_mov_b32 m0, s73
    s_nop 0
    buffer_load_dwordx4 v4, s[24:27], s74 offen offset:0 lds
    v_add_u32 v4, 9216, v4
    buffer_load_dwordx4 v4, s[24:27], s74 offen offset:1024 lds
    v_add_u32 v4, 9216, v4
    buffer_load_dwordx4 v4, s[24:27], s74 offen offset:2048 lds
    v_add_u32 v4, 9216, v4
    buffer_load_dwordx4 v4, s[24:27], s74 offen offset:3072 lds
    s_mul_i32 s54, s75, 5120
    s_add_u32 s75, s54, 524288
    v_lshrrev_b32 v5, 2, v1
    v_lshlrev_b32 v5, 7, v5
    v_and_b32 v6, 3, v1
    v_lshl_add_u32 v5, v6, 3, v5
    v_add_u32_e64 v24, s73, v5
    s_waitcnt vmcnt(16)
    ds_read_b128 a[128:131], v8 offset:8192
    ds_read_b128 a[132:135], v9 offset:8192
    ds_read_b128 a[136:139], v10 offset:8192
    ds_read_b128 a[140:143], v11 offset:8192
    v_mov_b32 v248, -1
    v_mov_b32 v249, -1
    v_mov_b32 v250, -1
    v_mov_b32_e64 v251, -1
    s_add_u32 s70, s78, 0
    buffer_store_dwordx4 v[248:251], v2, s[16:19], s70 offen sc1
    s_add_u32 s70, s78, 32768
    buffer_store_dwordx4 v[248:251], v2, s[16:19], s70 offen sc1
    s_add_u32 s70, s78, 65536
    buffer_store_dwordx4 v[248:251], v2, s[16:19], s70 offen sc1
    s_waitcnt vmcnt(15)
    s_nop 0
    ds_read_b128 a[144:147], v8 offset:12288
    ds_read_b128 a[148:151], v9 offset:12288
    ds_read_b128 a[152:155], v10 offset:12288
    ds_read_b128 a[156:159], v11 offset:12288
    s_waitcnt lgkmcnt(12)
    s_add_u32 m0, s72, 0
    s_add_u32 s74, s35, s36
    buffer_load_dwordx4 v16, s[12:15], s74 offen offset:0 lds
    s_waitcnt vmcnt(12)
    ds_read_b128 a[160:163], v8 offset:16384
    ds_read_b128 a[164:167], v9 offset:16384
    ds_read_b128 a[168:171], v10 offset:16384
    ds_read_b128 a[172:175], v11 offset:16384
    buffer_load_dwordx4 v17, s[12:15], s74 offen offset:1024 lds
    buffer_load_dwordx4 v18, s[12:15], s74 offen offset:2048 lds
    buffer_load_dwordx4 v19, s[12:15], s74 offen offset:3072 lds
    s_waitcnt vmcnt(11)
    ds_read_b128 a[176:179], v8 offset:20480
    s_nop 0
    ds_read_b128 a[180:183], v9 offset:20480
    ds_read_b128 a[184:187], v10 offset:20480
    ds_read_b128 a[188:191], v11 offset:20480
    s_waitcnt lgkmcnt(15)
    s_nop 0
    s_add_u32 m0, s72, 4096
    s_add_u32 s74, s35, s37
    buffer_load_dwordx4 v16, s[12:15], s74 offen offset:0 lds
    buffer_load_dwordx4 v17, s[12:15], s74 offen offset:1024 lds
    s_nop 0
    buffer_load_dwordx4 v18, s[12:15], s74 offen offset:2048 lds
    buffer_load_dwordx4 v19, s[12:15], s74 offen offset:3072 lds
    s_waitcnt vmcnt(11)
    ds_read_b64_tr_b16 v[84:85], v24 offset:0
    s_nop 0
    ds_read_b64_tr_b16 v[86:87], v24 offset:2048
    ds_read_b64_tr_b16 v[88:89], v24 offset:32
    ds_read_b64_tr_b16 v[90:91], v24 offset:2080
    ds_read_b64_tr_b16 v[92:93], v24 offset:64
    ds_read_b64_tr_b16 v[94:95], v24 offset:2112
    ds_read_b64_tr_b16 v[96:97], v24 offset:96
    ds_read_b64_tr_b16 v[98:99], v24 offset:2144
    s_cmp_ge_u32 s76, 5
    s_cselect_b32 s71, 4, 0
    s_cselect_b32 s70, 5, 0
    s_sub_u32 s70, s76, s70
    s_cmp_lt_u32 s70, 4
    s_cselect_b32 s0, 0, 0
    v_xor_b32 v32, s0, v2
    s_cselect_b32 s0, s70, 0
    s_cselect_b32 s70, 0, 4
    s_add_u32 s71, s71, s0
    s_lshl_b32 s70, s70, 10
    s_mul_i32 s0, s71, 122880
    s_add_u32 s70, s70, s0
    s_add_u32 s58, s70, s75
    s_waitcnt lgkmcnt(6)
    buffer_store_dwordx4 v[84:87], v32, s[16:19], s58 offen sc1
    s_cmp_ge_u32 s76, 5
    s_cselect_b32 s71, 4, 0
    s_cselect_b32 s70, 5, 0
    s_sub_u32 s70, s76, s70
    s_cmp_lt_u32 s70, 4
    s_cselect_b32 s0, 16, 0
    v_xor_b32 v33, s0, v2
    s_cselect_b32 s0, s70, 1
    s_cselect_b32 s70, 1, 4
    s_add_u32 s71, s71, s0
    s_lshl_b32 s70, s70, 10
    s_mul_i32 s0, s71, 122880
    s_add_u32 s70, s70, s0
    s_add_u32 s59, s70, s75
    s_waitcnt lgkmcnt(4)
    buffer_store_dwordx4 v[88:91], v33, s[16:19], s59 offen sc1
    s_cmp_ge_u32 s76, 5
    s_cselect_b32 s71, 4, 0
    s_cselect_b32 s70, 5, 0
    s_sub_u32 s70, s76, s70
    s_cmp_lt_u32 s70, 4
    s_cselect_b32 s0, 32, 0
    v_xor_b32 v34, s0, v2
    s_cselect_b32 s0, s70, 2
    s_cselect_b32 s70, 2, 4
    s_add_u32 s71, s71, s0
    s_lshl_b32 s70, s70, 10
    s_mul_i32 s0, s71, 122880
    s_add_u32 s70, s70, s0
    s_add_u32 s60, s70, s75
    s_cmp_ge_u32 s76, 5
    s_cselect_b32 s71, 4, 0
    s_cselect_b32 s70, 5, 0
    s_sub_u32 s70, s76, s70
    s_cmp_lt_u32 s70, 4
    s_cselect_b32 s0, 48, 0
    v_xor_b32 v35, s0, v2
    s_cselect_b32 s0, s70, 3
    s_cselect_b32 s70, 3, 4
    s_add_u32 s71, s71, s0
    s_lshl_b32 s70, s70, 10
    s_mul_i32 s0, s71, 122880
    s_add_u32 s70, s70, s0
    s_add_u32 s61, s70, s75
    s_add_u32 m0, s72, 8192
    s_add_u32 s74, s35, s38
    buffer_load_dwordx4 v16, s[12:15], s74 offen offset:0 lds
    buffer_load_dwordx4 v17, s[12:15], s74 offen offset:1024 lds
    s_nop 0
    buffer_load_dwordx4 v18, s[12:15], s74 offen offset:2048 lds
    buffer_load_dwordx4 v19, s[12:15], s74 offen offset:3072 lds
    s_add_u32 m0, s72, 12288
    s_add_u32 s74, s35, s39
    s_nop 0
    buffer_load_dwordx4 v16, s[12:15], s74 offen offset:0 lds
    buffer_load_dword v49, v48, s[16:19], 0 offen sc1
    buffer_load_dwordx4 v17, s[12:15], s74 offen offset:1024 lds
    buffer_load_dwordx4 v18, s[12:15], s74 offen offset:2048 lds
    buffer_load_dwordx4 v19, s[12:15], s74 offen offset:3072 lds
    s_waitcnt vmcnt(15)
    ds_read_b128 a[192:195], v8 offset:0
    ds_read_b128 a[196:199], v9 offset:0
    s_nop 0
    ds_read_b128 a[200:203], v10 offset:0
    ds_read_b128 a[204:207], v11 offset:0
    s_waitcnt vmcnt(11)
    ds_read_b128 a[208:211], v8 offset:4096
    s_nop 0
    ds_read_b128 a[212:215], v9 offset:4096
    ds_read_b128 a[216:219], v10 offset:4096
    ds_read_b128 a[220:223], v11 offset:4096
    s_waitcnt vmcnt(3)
    v_cmp_ne_u32 vcc, v49, v43
    s_cbranch_vccnz L_slow3
L_ok3:
    buffer_load_dwordx4 v[116:119], v3, s[16:19], s40 offen offset:0 sc1
    buffer_load_dwordx4 v[120:123], v3, s[16:19], s40 offen offset:1024 sc1
    buffer_load_dwordx4 v[124:127], v3, s[16:19], s40 offen offset:2048 sc1
    s_nop 0
    buffer_load_dwordx4 v[128:131], v3, s[16:19], s40 offen offset:3072 sc1
    buffer_load_dwordx4 v[132:135], v3, s[16:19], s41 offen offset:0 sc1
    ds_read_b128 a[224:227], v8 offset:8192
    ds_read_b128 a[228:231], v9 offset:8192
    ds_read_b128 a[232:235], v10 offset:8192
    ds_read_b128 a[236:239], v11 offset:8192
    buffer_load_dwordx4 v[136:139], v3, s[16:19], s41 offen offset:1024 sc1
    buffer_load_dwordx4 v[140:143], v3, s[16:19], s41 offen offset:2048 sc1
    buffer_load_dwordx4 v[144:147], v3, s[16:19], s41 offen offset:3072 sc1
    s_waitcnt vmcnt(8)
    ds_read_b128 a[240:243], v8 offset:12288
    ds_read_b128 a[244:247], v9 offset:12288
    s_nop 0
    ds_read_b128 a[248:251], v10 offset:12288
    ds_read_b128 a[252:255], v11 offset:12288
    buffer_load_dwordx4 v[148:151], v3, s[16:19], s42 offen offset:0 sc1
    buffer_load_dwordx4 v[152:155], v3, s[16:19], s42 offen offset:1024 sc1
    buffer_load_dwordx4 v[156:159], v3, s[16:19], s42 offen offset:2048 sc1
    buffer_load_dwordx4 v[160:163], v3, s[16:19], s42 offen offset:3072 sc1
    buffer_load_dwordx4 v[164:167], v3, s[16:19], s43 offen offset:0 sc1
    buffer_load_dwordx4 v[168:171], v3, s[16:19], s43 offen offset:1024 sc1
    s_waitcnt lgkmcnt(0)
    s_nop 1
    s_branch L_join
L_slow1:
    s_mov_b32 s3, 0
L_spin1:
    buffer_load_dwordx4 v[236:239], v41, s[16:19], s75 offen offset:0 sc1
    buffer_load_dwordx4 v[240:243], v41, s[16:19], s75 offen offset:1024 sc1
    buffer_load_dwordx4 v[244:247], v41, s[16:19], s75 offen offset:2048 sc1
    s_add_u32 s3, s3, 1
    s_cmp_ge_u32 s3, 1048576
    s_waitcnt vmcnt(0)
    s_cbranch_scc1 L_ok1
    v_xor_b32 v247, v255, v247
    v_xor_b32 v246, v254, v246
    v_xor_b32 v245, v253, v245
    v_xor_b32 v244, v252, v244
    v_xor_b32 v243, v255, v243
    v_xor_b32 v242, v254, v242
    v_xor_b32 v241, v253, v241
    v_xor_b32 v240, v252, v240
    v_xor_b32 v239, v255, v239
    v_xor_b32 v238, v254, v238
    v_xor_b32 v237, v253, v237
    v_xor_b32_e64 v236, v252, v236
    v_or3_b32 v32, v247, v246, v245
    v_or3_b32 v33, v244, v243, v242
    v_or3_b32 v32, v32, v241, v240
    v_or3_b32 v33, v33, v239, v238
    v_or3_b32 v32, v32, v237, v236
    v_or_b32_e64 v32, v32, v33
    v_and_b32 v32, 0xff, v32
    v_cmp_ne_u32 vcc, 0, v32
    s_cbranch_vccnz L_spin1
    s_branch L_ok1
L_slow2:
    s_mov_b32 s3, 0
L_spin2:
    buffer_load_dword v49, v48, s[16:19], 0 offen sc1
    s_add_u32 s3, s3, 1
    s_cmp_ge_u32 s3, 1048576
    s_waitcnt vmcnt(0)
    s_cbranch_scc1 L_ok2
    v_cmp_ne_u32 vcc, v49, v43
    s_cbranch_vccnz L_spin2
    s_branch L_ok2
L_slow3:
    s_mov_b32 s3, 0
L_spin3:
    buffer_load_dword v49, v48, s[16:19], 0 offen sc1
    s_add_u32 s3, s3, 1
    s_cmp_ge_u32 s3, 1048576
    s_waitcnt vmcnt(0)
    s_cbranch_scc1 L_ok3
    v_cmp_ne_u32 vcc, v49, v43
    s_cbranch_vccnz L_spin3
    s_branch L_ok3
L_pollA:
    buffer_load_dword v49, v44, s[16:19], 0 offen sc1
    s_branch L_pollAr
L_slow4:
    s_mov_b32 s3, 0
L_spin4:
    s_nop 0
    buffer_load_dword v49, v44, s[16:19], 0 offen sc1
    s_add_u32 s3, s3, 1
    s_cmp_ge_u32 s3, 1048576
    s_waitcnt vmcnt(0)
    s_cbranch_scc1 L_ok4
    v_cmp_ne_u32 vcc, v49, v43
    s_cbranch_vccnz L_spin4
    s_branch L_ok4
L_slow5:
    s_mov_b32 s3, 0
L_spin5:
    buffer_load_dword v49, v45, s[16:19], 0 offen sc1
    s_add_u32 s3, s3, 1
    s_cmp_ge_u32 s3, 1048576
    s_waitcnt vmcnt(0)
    s_cbranch_scc1 L_ok5
    v_cmp_ne_u32 vcc, v49, v43
    s_cbranch_vccnz L_spin5
    s_branch L_ok5
L_z1ld:
    s_waitcnt vmcnt(10)
    v_cmp_ne_u32 vcc, v49, v43
    s_cbranch_vccnz L_slow4
L_ok4:
    buffer_load_dwordx4 v[236:239], v32, s[16:19], s79 offen offset:0 sc1
    buffer_load_dwordx4 v[240:243], v32, s[16:19], s79 offen offset:1024 sc1
    s_branch L_z1ldr
L_unpack:
    s_waitcnt vmcnt(13)
    v_lshlrev_b32_e64 v180, 16, v236
    v_and_b32 v181, 0xffff0000, v236
    v_lshlrev_b32 v182, 16, v237
    v_and_b32 v183, 0xffff0000, v237
    v_lshlrev_b32 v184, 16, v238
    v_and_b32 v185, 0xffff0000, v238
    v_lshlrev_b32 v186, 16, v239
    v_and_b32 v187, 0xffff0000, v239
    v_lshlrev_b32 v188, 16, v240
    v_and_b32 v189, 0xffff0000, v240
    v_lshlrev_b32_e64 v190, 16, v241
    v_and_b32 v191, 0xffff0000, v241
    v_lshlrev_b32 v192, 16, v242
    v_and_b32 v193, 0xffff0000, v242
    v_lshlrev_b32 v194, 16, v243
    v_and_b32 v195, 0xffff0000, v243
    s_branch L_unpackr
L_epoch:
    buffer_store_dword v43, v0, s[16:19], 0 offen offset:0 sc1
    s_branch L_epochr
L_slow6:
    s_mov_b32 s3, 0
L_spin6:
    buffer_load_dwordx4 v[196:199], v2, s[16:19], s33 offen sc1
    s_nop 0
    buffer_load_dwordx4 v[200:203], v2, s[16:19], s34 offen sc1
    buffer_load_dwordx4 v[204:207], v2, s[16:19], s35 offen sc1
    buffer_load_dwordx4 v[208:211], v2, s[16:19], s36 offen sc1
    buffer_load_dwordx4 v[116:119], v2, s[16:19], s37 offen sc1
    buffer_load_dwordx4 v[120:123], v2, s[16:19], s38 offen sc1
    buffer_load_dwordx4 v[124:127], v2, s[16:19], s39 offen sc1
    s_add_u32 s3, s3, 1
    s_cmp_ge_u32 s3, 1048576
    s_waitcnt vmcnt(0)
    s_cbranch_scc1 L_ok6
    v_max3_u32 v4, v199, v203, v207
    v_max3_u32 v4, v4, v211, v119
    v_max3_u32 v4, v4, v123, v127
    v_cmp_eq_u32 vcc, -1, v4
    s_cbranch_vccnz L_spin6
    s_branch L_ok6
L_slow7:
    s_mov_b32 s3, 0
L_spin7:
    buffer_load_dwordx4 v[128:131], v8, s[16:19], s33 offen sc1
    buffer_load_dwordx4 v[132:135], v8, s[16:19], s34 offen sc1
    s_nop 0
    buffer_load_dwordx4 v[136:139], v8, s[16:19], s35 offen sc1
    buffer_load_dwordx4 v[140:143], v8, s[16:19], s36 offen sc1
    buffer_load_dwordx4 v[144:147], v8, s[16:19], s37 offen sc1
    buffer_load_dwordx4 v[148:151], v8, s[16:19], s38 offen sc1
    buffer_load_dwordx4 v[152:155], v8, s[16:19], s39 offen sc1
    s_add_u32 s3, s3, 1
    s_cmp_ge_u32 s3, 1048576
    s_waitcnt vmcnt(0)
    s_cbranch_scc1 L_ok7
    v_cmp_eq_u32 vcc, -1, v131
    s_cbranch_vccnz L_spin7
    s_branch L_ok7
L_slow8:
    s_mov_b32 s3, 0
L_spin8:
    buffer_load_dwordx4 v[132:135], v8, s[16:19], s34 offen sc1
    buffer_load_dwordx4 v[136:139], v8, s[16:19], s35 offen sc1
    s_nop 0
    buffer_load_dwordx4 v[140:143], v8, s[16:19], s36 offen sc1
    buffer_load_dwordx4 v[144:147], v8, s[16:19], s37 offen sc1
    buffer_load_dwordx4 v[148:151], v8, s[16:19], s38 offen sc1
    buffer_load_dwordx4 v[152:155], v8, s[16:19], s39 offen sc1
    s_add_u32 s3, s3, 1
    s_cmp_ge_u32 s3, 1048576
    s_waitcnt vmcnt(0)
    s_cbranch_scc1 L_ok8
    v_max_u32 v4, v135, v139
    v_cmp_eq_u32 vcc, -1, v4
    s_cbranch_vccnz L_spin8
    s_branch L_ok8
L_slow9:
    s_mov_b32 s3, 0
L_spin9:
    buffer_load_dwordx4 v[140:143], v8, s[16:19], s36 offen sc1
    buffer_load_dwordx4 v[144:147], v8, s[16:19], s37 offen sc1
    buffer_load_dwordx4 v[148:151], v8, s[16:19], s38 offen sc1
    buffer_load_dwordx4 v[152:155], v8, s[16:19], s39 offen sc1
    s_add_u32 s3, s3, 1
    s_cmp_ge_u32 s3, 1048576
    s_waitcnt vmcnt(0)
    s_cbranch_scc1 L_ok9
    v_max_u32 v4, v143, v147
    v_cmp_eq_u32 vcc, -1, v4
    s_cbranch_vccnz L_spin9
    s_branch L_ok9
L_slow10:
    s_mov_b32 s3, 0
L_spin10:
    buffer_load_dwordx4 v[148:151], v8, s[16:19], s38 offen sc1
    buffer_load_dwordx4 v[152:155], v8, s[16:19], s39 offen sc1
    s_add_u32 s3, s3, 1
    s_cmp_ge_u32 s3, 1048576
    s_waitcnt vmcnt(0)
    s_cbranch_scc1 L_ok10
    v_max_u32 v4, v151, v155
    v_cmp_eq_u32 vcc, -1, v4
    s_cbranch_vccnz L_spin10
    s_branch L_ok10
L_slow11:
    s_mov_b32 s3, 0
L_spin11:
    buffer_load_dwordx4 v[84:87], v9, s[16:19], s33 offen sc1
    buffer_load_dwordx4 v[88:91], v9, s[16:19], s34 offen sc1
    buffer_load_dwordx4 v[92:95], v9, s[16:19], s35 offen sc1
    buffer_load_dwordx4 v[96:99], v9, s[16:19], s36 offen sc1
    buffer_load_dwordx4 v[100:103], v9, s[16:19], s37 offen sc1
    buffer_load_dwordx4 v[104:107], v9, s[16:19], s38 offen sc1
    buffer_load_dwordx4 v[108:111], v9, s[16:19], s39 offen sc1
    s_add_u32 s3, s3, 1
    s_cmp_ge_u32 s3, 1048576
    s_waitcnt vmcnt(0)
    s_cbranch_scc1 L_ok11
    v_cmp_eq_u32 vcc, -1, v87
    s_cbranch_vccnz L_spin11
    s_branch L_ok11
L_slow12:
    s_mov_b32 s3, 0
L_spin12:
    buffer_load_dwordx4 v[88:91], v9, s[16:19], s34 offen sc1
    buffer_load_dwordx4 v[92:95], v9, s[16:19], s35 offen sc1
    buffer_load_dwordx4 v[96:99], v9, s[16:19], s36 offen sc1
    s_nop 0
    buffer_load_dwordx4 v[100:103], v9, s[16:19], s37 offen sc1
    buffer_load_dwordx4 v[104:107], v9, s[16:19], s38 offen sc1
    buffer_load_dwordx4 v[108:111], v9, s[16:19], s39 offen sc1
    s_add_u32 s3, s3, 1
    s_nop 0
    s_cmp_ge_u32 s3, 1048576
    s_waitcnt vmcnt(0)
    s_cbranch_scc1 L_ok12
    v_max_u32 v4, v91, v95
    v_cmp_eq_u32 vcc, -1, v4
    s_cbranch_vccnz L_spin12
    s_branch L_ok12
L_slow13:
    s_mov_b32 s3, 0
L_spin13:
    buffer_load_dwordx4 v[96:99], v9, s[16:19], s36 offen sc1
    buffer_load_dwordx4 v[100:103], v9, s[16:19], s37 offen sc1
    buffer_load_dwordx4 v[104:107], v9, s[16:19], s38 offen sc1
    s_nop 0
    buffer_load_dwordx4 v[108:111], v9, s[16:19], s39 offen sc1
    s_add_u32 s3, s3, 1
    s_cmp_ge_u32 s3, 1048576
    s_waitcnt vmcnt(0)
    s_cbranch_scc1 L_ok13
    v_cmp_eq_u32 vcc, -1, v99
    s_cbranch_vccnz L_spin13
    s_branch L_ok13
L_slow14:
    s_mov_b32 s3, 0
L_spin14:
    buffer_load_dwordx4 v[100:103], v9, s[16:19], s37 offen sc1
    buffer_load_dwordx4 v[104:107], v9, s[16:19], s38 offen sc1
    s_nop 0
    buffer_load_dwordx4 v[108:111], v9, s[16:19], s39 offen sc1
    s_add_u32 s3, s3, 1
    s_cmp_ge_u32 s3, 1048576
    s_waitcnt vmcnt(0)
    s_cbranch_scc1 L_ok14
    v_cmp_eq_u32 vcc, -1, v103
    s_cbranch_vccnz L_spin14
    s_branch L_ok14
L_slow15:
    s_mov_b32 s3, 0
L_spin15:
    buffer_load_dwordx4 v[104:107], v9, s[16:19], s38 offen sc1
    buffer_load_dwordx4 v[108:111], v9, s[16:19], s39 offen sc1
    s_add_u32 s3, s3, 1
    s_cmp_ge_u32 s3, 1048576
    s_waitcnt vmcnt(0)
    s_cbranch_scc1 L_ok15
    v_cmp_eq_u32 vcc, -1, v107
    s_cbranch_vccnz L_spin15
    s_branch L_ok15
L_slow16:
    s_mov_b32 s3, 0
L_spin16:
    buffer_load_dwordx4 v[108:111], v9, s[16:19], s39 offen sc1
    s_add_u32 s3, s3, 1
    s_cmp_ge_u32 s3, 1048576
    s_waitcnt vmcnt(0)
    s_cbranch_scc1 L_ok16
    v_cmp_eq_u32 vcc, -1, v111
    s_cbranch_vccnz L_spin16
    s_branch L_ok16
L_exit:
    s_endpgm
L_code_end:
.section .rodata,"a"
.p2align 6
.amdhsa_kernel standalone__mixer_gmlp__prompt_kernel
  .amdhsa_next_free_vgpr 512
  .amdhsa_next_free_sgpr 102
  .amdhsa_accum_offset 256
  .amdhsa_group_segment_fixed_size 0
  .amdhsa_kernarg_size 64
  .amdhsa_user_sgpr_count 2
  .amdhsa_user_sgpr_kernarg_segment_ptr 1
  .amdhsa_system_sgpr_workgroup_id_x 1
.end_amdhsa_kernel
```
